```python
import torch

def _softmax(x, axis=-1):
    return torch.softmax(x, dim=axis)
def _gelu(x):
    return torch.nn.functional.gelu(x, approximate="tanh")
def _silu(x):
    return torch.nn.functional.silu(x)
def _sigmoid(x):
    return torch.sigmoid(x)
def _layernorm(x, axis=-1, eps=1e-5):
    m = x.mean(dim=axis, keepdim=True)
    v = x.var(dim=axis, keepdim=True, unbiased=False)
    return (x - m) / torch.sqrt(v + eps)
def _scatter_add(tgt, idx, src, axis=0):
    return tgt.clone().index_add_(axis, idx, src)
def _segment_sum(src, seg, n):
    out = torch.zeros((n,) + src.shape[1:], dtype=src.dtype)
    return out.index_add_(0, seg, src)
def _pad(x, pw):
    flat = tuple(v for pair in reversed(pw) for v in pair)
    return torch.nn.functional.pad(x, flat)

kernel_name = 'standalone__edge_featured_mpnn_gatedgcn__graph'

def setup_inputs():

    _w = (lambda a: (lambda t: t.to(torch.bfloat16) if t.is_floating_point() else t)(torch.as_tensor(a)))
    N, deg, D, De = 12500, 64, 64, max(0, 1)
    E = N * deg
    return {
        "x": _w((lambda *s: torch.randn(*s, dtype=torch.bfloat16) * 0.8)(N, D)),
        "e_attr": _w((lambda *s: torch.randn(*s, dtype=torch.bfloat16) * 0.8)(E, De)),
        "src": _w((lambda lo, hi, *s: torch.randint(lo, hi, s))(0, N, E).to(torch.int64)),
        "dst": _w((lambda lo, hi, *s: torch.randint(lo, hi, s))(0, N, E).to(torch.int64)),
        "w_a": _w((lambda *s: torch.randn(*s, dtype=torch.bfloat16) * 0.8)(D, D)),
        "w_b": _w((lambda *s: torch.randn(*s, dtype=torch.bfloat16) * 0.8)(D, D)),
        "w_c": _w((lambda *s: torch.randn(*s, dtype=torch.bfloat16) * 0.8)(De, D)),
        "w_u": _w((lambda *s: torch.randn(*s, dtype=torch.bfloat16) * 0.05)(D, D)),
        "w_v": _w((lambda *s: torch.randn(*s, dtype=torch.bfloat16) * 0.05)(D, D)),
    }

def reference(x, e_attr, src, dst, w_a, w_b, w_c, w_u, w_v):
    N, D = x.shape
    hv = x @ w_v
    g = x[dst] @ w_a + x[src] @ w_b + e_attr @ w_c
    eta = _sigmoid(g)
    denom = _segment_sum(eta, dst, N) + 1e-6
    eta_n = eta / denom[dst]
    agg = _segment_sum(eta_n * hv[src], dst, N)
    z = x @ w_u + agg
    relu_z = torch.where(z > 0, z, 0 * z)
    return x + relu_z
```

```asm
; @launch kernel=standalone__edge_featured_mpnn_gatedgcn__graph_kernel grid=(256,1,1) block=(1024,1,1) lds=156544
.amdgcn_target "amdgcn-amd-amdhsa--gfx950"
.text
.p2align 8
.globl standalone__edge_featured_mpnn_gatedgcn__graph_kernel
.type standalone__edge_featured_mpnn_gatedgcn__graph_kernel,@function
standalone__edge_featured_mpnn_gatedgcn__graph_kernel:
    s_cmp_ge_u32 s2, 256
    s_cbranch_scc1 K_END
    s_load_dwordx16 s[4:19], s[0:1], 0
    s_load_dwordx8 s[20:27], s[0:1], 64
    s_getpc_b64 s[64:65]
A_PC:
    v_lshlrev_b32 v8, 7, v0
    v_cmp_gt_u32 vcc, K_SLOW-A_PC, v8
    s_and_b64 exec, exec, vcc
    s_cbranch_execz A_NOPF
    global_load_dword v27, v8, s[64:65]
A_NOPF:
    s_mov_b64 exec, -1
    v_lshrrev_b32 v1, 6, v0
    v_and_b32 v2, 7, v0
    v_readfirstlane_b32 s3, v1
    v_lshrrev_b32 v3, 3, v0
    s_cmp_ge_u32 s3, 12
    s_cbranch_scc0 E_ALL
    s_setprio 3
    v_and_b32 v7, 7, v3
    s_and_b32 s64, s3, 1
    s_lshl_b32 s64, s64, 2
    v_and_b32 v8, 2, v7
    v_xor_b32 v8, v8, v2
    v_xor_b32 v8, s64, v8
    v_lshlrev_b32 v8, 4, v8
    v_lshl_add_u32 v8, v7, 7, v8
    s_and_b32 s78, s3, 3
    s_lshl_b32 s78, s78, 11
    v_add_u32 v126, s78, v8
    s_add_u32 s78, s78, 123776
    s_add_u32 s66, s3, 3
    s_and_b32 s66, s66, 3
    v_xor_b32 v9, v2, v7
    v_lshlrev_b32 v9, 4, v9
    v_lshl_add_u32 v9, v7, 15, v9
    s_lshl_b32 s67, s66, 19
    s_lshl_b32 s68, s2, 7
    s_add_u32 s67, s67, s68
    v_add_u32 v9, s67, v9
    v_add_u32 v15, 0x40000, v9
    s_lshl_b32 s67, s66, 11
    s_mov_b32 s34, 1600000
    s_mov_b32 s35, 0x20000
    s_mov_b32 m0, s67
    s_or_b32 s64, s2, s66
    s_waitcnt lgkmcnt(0)
    s_mov_b64 s[32:33], s[4:5]
    buffer_load_dwordx4 v9, s[32:35], 0 offen lds
    s_add_u32 m0, s67, 1024
    s_nop 0
    buffer_load_dwordx4 v15, s[32:35], 0 offen lds
    s_add_u32 m0, s78, 0
    s_nop 0
    global_load_lds_dwordx4 v126, s[14:15]
    global_load_lds_dwordx4 v126, s[14:15] offset:1024
    s_add_u32 m0, s78, 8192
    s_nop 0
    global_load_lds_dwordx4 v126, s[20:21]
    global_load_lds_dwordx4 v126, s[20:21] offset:1024
E_ALL:
    s_mul_i32 s64, s2, 12544
    v_lshl_add_u32 v10, v0, 4, s64
    v_lshrrev_b32 v11, 1, v10
    v_cmp_gt_u32 vcc, 784, v0
    s_mov_b64 s[74:75], vcc
    v_cmp_gt_u32 vcc, 3200000, v10
    s_and_b64 s[74:75], s[74:75], vcc
    s_mov_b32 s79, 0
    v_add_u32 v5, s2, v3
    v_and_b32 v5, 127, v5
    v_mul_u32_u24 v4, 272, v5
    v_lshl_add_u32 v4, v2, 4, v4
    v_lshlrev_b32 v5, 2, v5
    v_mov_b32 v12, 0
    v_mov_b32 v13, 0x3f3f3f
    s_waitcnt lgkmcnt(0)
    ds_write2st64_b32 v5, v12, v12 offset0:33 offset1:35
    ds_write_b32 v4, v13 offset:12556
    ds_write_b32 v4, v13 offset:47372
    s_mov_b64 exec, s[74:75]
    s_cbranch_execz E_NOD
    global_load_dwordx4 v[16:19], v10, s[10:11]
E_NOD:
    s_mov_b64 exec, -1
    s_cmp_ge_u32 s3, 2
    s_cbranch_scc1 E_NOZ
    v_lshlrev_b32 v8, 4, v0
    v_mov_b64 v[28:29], 0
    v_mov_b64 v[30:31], 0
    ds_write_b128 v8, v[28:31] offset:9472
E_NOZ:
    s_waitcnt lgkmcnt(0)
    s_barrier
    s_mov_b64 exec, s[74:75]
    s_cbranch_execz E_NOS
    global_load_dwordx4 v[20:23], v10, s[8:9]
    global_load_dwordx2 v[24:25], v11, s[6:7]
E_NOS:
    s_mov_b64 exec, -1
    s_lshr_b32 s64, s2, 7
    s_lshl_b32 s64, s64, 14
    s_add_u32 s64, s64, 0x400000
    v_mul_u32_u24 v6, 8256, v5
    v_lshl_add_u32 v6, v0, 4, v6
    v_add_u32 v6, s64, v6
    v_add_u32 v7, 4227072, v6
    s_mul_i32 s64, s2, 33024
    s_add_u32 s64, s64, 0x400000
    v_lshl_add_u32 v2, v0, 4, s64
    v_add_u32 v3, 0x4000, v2
    s_mov_b32 s36, 0x0f0f0f0f
    s_mov_b32 s37, s36
    v_bfe_u32 v102, v0, 2, 1
    v_mul_u32_u24 v102, 262152, v102
    s_mov_b32 s39, 524304
    s_mov_b32 s40, 0xc000
    s_mov_b32 s41, 0xffc0c0c0
    s_mov_b32 s42, 3211264
    s_mov_b32 s43, 0
    s_mov_b32 s38, 0
    v_mov_b32 v1, 0
    s_mov_b32 s30, 12501
    s_mov_b32 s31, 0x20000
    s_cmp_ge_u32 s3, 12
    s_cbranch_scc1 G_MAIN
    s_cmp_eq_u32 s3, 1
    s_cbranch_scc0 A_NOEP
    s_add_u32 s70, s26, 0x380000
    s_addc_u32 s71, s27, 0
    s_load_dwordx2 s[72:73], s[70:71], 8
A_NOEP:
    s_mov_b64 exec, s[74:75]
    s_cbranch_execz A_NOBIN
    v_mov_b32 v14, 21846
    s_mov_b32 s68, 1026762
    s_mov_b32 s69, 0x05040100
    s_mov_b32 s70, 0x07060100
    s_waitcnt vmcnt(2)
    v_lshlrev_b32_sdwa v28, 2, v16 dst_sel:DWORD dst_unused:UNUSED_PAD src0_sel:DWORD src1_sel:BYTE_0
    ds_add_rtn_u32 v32, v28, v14 offset:8448
    v_lshlrev_b32_sdwa v29, 2, v17 dst_sel:DWORD dst_unused:UNUSED_PAD src0_sel:DWORD src1_sel:BYTE_0
    ds_add_rtn_u32 v33, v29, v14 offset:8448
    v_lshlrev_b32_sdwa v30, 2, v18 dst_sel:DWORD dst_unused:UNUSED_PAD src0_sel:DWORD src1_sel:BYTE_0
    ds_add_rtn_u32 v34, v30, v14 offset:8448
    v_lshlrev_b32_sdwa v31, 2, v19 dst_sel:DWORD dst_unused:UNUSED_PAD src0_sel:DWORD src1_sel:BYTE_0
    ds_add_rtn_u32 v35, v31, v14 offset:8448
    v_mul_u32_u24 v28, 68, v28
    v_lshrrev_b32 v16, 8, v16
    v_mul_u32_u24 v29, 68, v29
    v_lshrrev_b32 v17, 8, v17
    v_mul_u32_u24 v30, 68, v30
    v_lshrrev_b32 v18, 8, v18
    v_mul_u32_u24 v31, 68, v31
    v_lshrrev_b32 v19, 8, v19
    s_waitcnt lgkmcnt(3)
    v_min_u32 v32, s68, v32
    v_lshrrev_b32 v32, 14, v32
    v_lshl_add_u32 v36, v32, 2, v28
    v_and_b32 v32, 3, v32
    v_or3_b32 v32, v36, 12, v32
    ds_write_b8 v32, v16 offset:12544
    s_waitcnt lgkmcnt(3)
    v_min_u32 v33, s68, v33
    v_lshrrev_b32 v33, 14, v33
    v_lshl_add_u32 v37, v33, 2, v29
    v_and_b32 v33, 3, v33
    v_or3_b32 v33, v37, 12, v33
    ds_write_b8 v33, v17 offset:12544
    s_waitcnt lgkmcnt(3)
    v_min_u32 v34, s68, v34
    v_lshrrev_b32 v34, 14, v34
    v_lshl_add_u32 v38, v34, 2, v30
    v_and_b32 v34, 3, v34
    v_or3_b32 v34, v38, 12, v34
    ds_write_b8 v34, v18 offset:12544
    s_waitcnt lgkmcnt(3)
    v_min_u32 v35, s68, v35
    v_lshrrev_b32 v35, 14, v35
    v_lshl_add_u32 v39, v35, 2, v31
    v_and_b32 v35, 3, v35
    v_or3_b32 v35, v39, 12, v35
    ds_write_b8 v35, v19 offset:12544
    s_waitcnt vmcnt(0)
    v_perm_b32 v20, v24, v20, s69
    ds_write_b32 v36, v20 offset:12544
    v_perm_b32 v21, v24, v21, s70
    ds_write_b32 v37, v21 offset:12544
    v_perm_b32 v22, v25, v22, s69
    ds_write_b32 v38, v22 offset:12544
    v_perm_b32 v23, v25, v23, s70
    ds_write_b32 v39, v23 offset:12544
A_NOBIN:
    s_mov_b64 exec, -1
    s_cmp_eq_u32 s3, 1
    s_cbranch_scc0 A_JOIN
    s_waitcnt lgkmcnt(0)
    s_add_u32 s72, s72, 0x1000000
    s_addc_u32 s73, s73, 0
    s_and_b32 s72, s72, 0xff000000
    s_bfe_u32 s64, s73, 0x20000
    s_lshl_b32 s64, s64, 6
    s_or_b32 s72, s72, s64
    s_bfe_u32 s64, s73, 0x20002
    s_lshl_b32 s64, s64, 14
    s_or_b32 s72, s72, s64
    s_bfe_u32 s64, s73, 0x20004
    s_lshl_b32 s64, s64, 22
    s_or_b32 s72, s72, s64
    s_lshr_b32 s64, s72, 10
    s_and_b32 s64, s64, 0xc000
    v_mov_b32 v122, s64
    v_mov_b32 v123, s72
    ds_write_b64 v1, v[122:123] offset:9744
    s_branch A_JOIN
G_MAIN:
    s_mov_b32 s48, 0
    s_mov_b32 s35, 0x20000
    v_and_b32 v126, 0x1bf0, v126
    v_and_b32 v100, 7, v0
    v_lshlrev_b32 v100, 4, v100
    s_mov_b32 s34, 3200256
    v_and_b32 v124, 15, v0
    v_bfe_u32 v125, v0, 4, 2
    v_and_b32 v8, 7, v124
    v_lshlrev_b32 v9, 1, v125
    v_xor_b32 v8, v8, v9
    v_lshlrev_b32 v8, 4, v8
    v_lshl_add_u32 v8, v124, 7, v8
    v_add_u32 v8, s67, v8
    v_xor_b32 v9, 16, v8
    v_lshrrev_b32 v10, 2, v124
    v_and_b32 v11, 2, v10
    v_bfe_u32 v12, v0, 1, 1
    v_or_b32 v11, v11, v12
    v_and_b32 v12, 1, v125
    v_lshl_or_b32 v11, v12, 2, v11
    v_lshlrev_b32 v11, 4, v11
    v_and_b32 v12, 1, v0
    v_lshl_or_b32 v11, v12, 3, v11
    v_lshl_add_u32 v10, v125, 4, v10
    v_lshl_or_b32 v11, v10, 7, v11
    v_add_u32 v12, 123776, v11
    v_xor_b32 v13, 32, v12
    v_xor_b32 v14, 64, v12
    v_xor_b32 v15, 96, v12
    s_mov_b32 s76, 0xbfb8aa3b
    s_mov_b32 s77, 0x07060302
    v_mov_b32 v26, 0x1c800000
    s_lshl_b32 s64, s66, 20
    s_lshl_b32 s65, s2, 8
    s_add_u32 s64, s64, s65
    v_lshlrev_b32 v27, 18, v125
    v_lshl_add_u32 v27, v124, 4, v27
    v_add_u32 v27, s64, v27
    v_mov_b32 v10, 1
    s_cmp_eq_u64 s[74:75], 0
    s_cbranch_scc1 G_W0
    s_waitcnt vmcnt(3)
    s_branch G_W1
G_W0:
    s_waitcnt vmcnt(0)
G_W1:
    s_mov_b64 exec, 1
    ds_add_u32 v1, v10 offset:9732
    s_mov_b64 exec, -1
G_S1:
    ds_read_b32 v11, v1 offset:9732
    s_waitcnt lgkmcnt(0)
    v_readfirstlane_b32 s64, v11
    s_cmp_lt_u32 s64, 4
    s_cbranch_scc1 G_S1
    ds_read_b128 v[28:31], v8
    ds_read_b128 v[32:35], v9
    ds_read_b64_tr_b16 v[36:37], v12 offset:0
    ds_read_b64_tr_b16 v[38:39], v12 offset:512
    ds_read_b64_tr_b16 v[40:41], v12 offset:1024
    ds_read_b64_tr_b16 v[42:43], v12 offset:1536
    ds_read_b64_tr_b16 v[44:45], v13 offset:0
    ds_read_b64_tr_b16 v[46:47], v13 offset:512
    ds_read_b64_tr_b16 v[48:49], v13 offset:1024
    ds_read_b64_tr_b16 v[50:51], v13 offset:1536
    ds_read_b64_tr_b16 v[52:53], v14 offset:0
    ds_read_b64_tr_b16 v[54:55], v14 offset:512
    ds_read_b64_tr_b16 v[56:57], v14 offset:1024
    ds_read_b64_tr_b16 v[58:59], v14 offset:1536
    ds_read_b64_tr_b16 v[60:61], v15 offset:0
    ds_read_b64_tr_b16 v[62:63], v15 offset:512
    ds_read_b64_tr_b16 v[64:65], v15 offset:1024
    ds_read_b64_tr_b16 v[66:67], v15 offset:1536
    ds_read_b64_tr_b16 v[68:69], v12 offset:8192
    ds_read_b64_tr_b16 v[70:71], v12 offset:8704
    ds_read_b64_tr_b16 v[72:73], v12 offset:9216
    ds_read_b64_tr_b16 v[74:75], v12 offset:9728
    ds_read_b64_tr_b16 v[76:77], v13 offset:8192
    ds_read_b64_tr_b16 v[78:79], v13 offset:8704
    ds_read_b64_tr_b16 v[80:81], v13 offset:9216
    ds_read_b64_tr_b16 v[82:83], v13 offset:9728
    ds_read_b64_tr_b16 v[84:85], v14 offset:8192
    ds_read_b64_tr_b16 v[86:87], v14 offset:8704
    ds_read_b64_tr_b16 v[88:89], v14 offset:9216
    ds_read_b64_tr_b16 v[90:91], v14 offset:9728
    ds_read_b64_tr_b16 v[92:93], v15 offset:8192
    ds_read_b64_tr_b16 v[94:95], v15 offset:8704
    ds_read_b64_tr_b16 v[96:97], v15 offset:9216
    ds_read_b64_tr_b16 v[98:99], v15 offset:9728
    s_add_u32 m0, s78, 16384
    s_nop 0
    global_load_lds_dwordx4 v126, s[12:13]
    global_load_lds_dwordx4 v126, s[12:13] offset:1024
    s_add_u32 m0, s78, 24576
    s_nop 0
    global_load_lds_dwordx4 v126, s[18:19]
    global_load_lds_dwordx4 v126, s[18:19] offset:1024
    s_cmp_eq_u32 s3, 13
    s_cbranch_scc0 G_NOWC
    s_mov_b32 m0, 8192
    s_mov_b64 exec, 0xff
    global_load_lds_dwordx4 v100, s[16:17]
    s_mov_b64 exec, -1
G_NOWC:
    s_waitcnt lgkmcnt(15)
    v_mfma_f32_16x16x32_bf16 v[104:107], v[28:31], v[36:39], 0
    v_mfma_f32_16x16x32_bf16 v[104:107], v[32:35], v[40:43], v[104:107]
    s_waitcnt lgkmcnt(15)
    v_mfma_f32_16x16x32_bf16 v[108:111], v[28:31], v[44:47], 0
    v_mfma_f32_16x16x32_bf16 v[108:111], v[32:35], v[48:51], v[108:111]
    s_waitcnt lgkmcnt(15)
    v_mfma_f32_16x16x32_bf16 v[112:115], v[28:31], v[52:55], 0
    v_mfma_f32_16x16x32_bf16 v[112:115], v[32:35], v[56:59], v[112:115]
    s_waitcnt lgkmcnt(15)
    v_mfma_f32_16x16x32_bf16 v[116:119], v[28:31], v[60:63], 0
    v_mfma_f32_16x16x32_bf16 v[116:119], v[32:35], v[64:67], v[116:119]
    s_waitcnt lgkmcnt(12)
    v_mfma_f32_16x16x32_bf16 v[36:39], v[28:31], v[68:71], 0
    v_mfma_f32_16x16x32_bf16 v[36:39], v[32:35], v[72:75], v[36:39]
    s_waitcnt lgkmcnt(8)
    v_mfma_f32_16x16x32_bf16 v[40:43], v[28:31], v[76:79], 0
    v_mfma_f32_16x16x32_bf16 v[40:43], v[32:35], v[80:83], v[40:43]
    s_waitcnt lgkmcnt(4)
    v_mfma_f32_16x16x32_bf16 v[44:47], v[28:31], v[84:87], 0
    v_mfma_f32_16x16x32_bf16 v[44:47], v[32:35], v[88:91], v[44:47]
    s_waitcnt lgkmcnt(0)
    v_mfma_f32_16x16x32_bf16 v[48:51], v[28:31], v[92:95], 0
    v_mfma_f32_16x16x32_bf16 v[48:51], v[32:35], v[96:99], v[48:51]
    s_mov_b32 s80, 0x8000
    s_mov_b32 s81, 0x8000
    s_mov_b32 s68, 0xd800000
    s_mov_b32 s69, s68
    v_mov_b32 v10, v26
    v_mov_b32 v11, v26
    s_nop 1
    v_pk_fma_f32 v[104:105], v[104:105], s[76:77], v[10:11] op_sel_hi:[1,0,1]
    v_pk_fma_f32 v[108:109], v[108:109], s[76:77], v[10:11] op_sel_hi:[1,0,1]
    v_pk_fma_f32 v[112:113], v[112:113], s[76:77], v[10:11] op_sel_hi:[1,0,1]
    v_pk_fma_f32 v[116:117], v[116:117], s[76:77], v[10:11] op_sel_hi:[1,0,1]
    v_pk_add_f32 v[40:41], v[40:41], s[68:69]
    v_pk_add_f32 v[48:49], v[48:49], s[68:69]
    v_lshl_add_u64 v[104:105], v[104:105], 0, s[80:81]
    v_lshl_add_u64 v[108:109], v[108:109], 0, s[80:81]
    v_lshl_add_u64 v[112:113], v[112:113], 0, s[80:81]
    v_lshl_add_u64 v[116:117], v[116:117], 0, s[80:81]
    v_lshl_add_u64 v[36:37], v[36:37], 0, s[80:81]
    v_lshl_add_u64 v[40:41], v[40:41], 0, s[80:81]
    v_lshl_add_u64 v[44:45], v[44:45], 0, s[80:81]
    v_lshl_add_u64 v[48:49], v[48:49], 0, s[80:81]
    v_sub_u32_sdwa v104, v104, v36 clamp dst_sel:DWORD dst_unused:UNUSED_PAD src0_sel:DWORD src1_sel:WORD_1
    v_sub_u32_sdwa v112, v112, v44 clamp dst_sel:DWORD dst_unused:UNUSED_PAD src0_sel:DWORD src1_sel:WORD_1
    v_sub_u32_sdwa v40, v40, v104 clamp dst_sel:DWORD dst_unused:UNUSED_PAD src0_sel:DWORD src1_sel:WORD_1
    v_sub_u32_sdwa v48, v48, v112 clamp dst_sel:DWORD dst_unused:UNUSED_PAD src0_sel:DWORD src1_sel:WORD_1
    v_sub_u32_sdwa v108, v108, v40 clamp dst_sel:DWORD dst_unused:UNUSED_PAD src0_sel:DWORD src1_sel:WORD_1
    v_sub_u32_sdwa v116, v116, v48 clamp dst_sel:DWORD dst_unused:UNUSED_PAD src0_sel:DWORD src1_sel:WORD_1
    v_perm_b32 v68, v104, v36, s77
    v_perm_b32 v69, v108, v40, s77
    v_perm_b32 v70, v112, v44, s77
    v_perm_b32 v71, v116, v48, s77
    s_mov_b64 s[32:33], s[26:27]
    s_cmp_eq_u32 s3, 12
    s_cbranch_scc1 G_T3
    buffer_store_dwordx4 v[68:71], v27, s[32:35], 0 offen sc1
    v_sub_u32_sdwa v105, v105, v37 clamp dst_sel:DWORD dst_unused:UNUSED_PAD src0_sel:DWORD src1_sel:WORD_1
    v_sub_u32_sdwa v113, v113, v45 clamp dst_sel:DWORD dst_unused:UNUSED_PAD src0_sel:DWORD src1_sel:WORD_1
    v_sub_u32_sdwa v41, v41, v105 clamp dst_sel:DWORD dst_unused:UNUSED_PAD src0_sel:DWORD src1_sel:WORD_1
    v_sub_u32_sdwa v49, v49, v113 clamp dst_sel:DWORD dst_unused:UNUSED_PAD src0_sel:DWORD src1_sel:WORD_1
    v_sub_u32_sdwa v109, v109, v41 clamp dst_sel:DWORD dst_unused:UNUSED_PAD src0_sel:DWORD src1_sel:WORD_1
    v_sub_u32_sdwa v117, v117, v49 clamp dst_sel:DWORD dst_unused:UNUSED_PAD src0_sel:DWORD src1_sel:WORD_1
    v_perm_b32 v72, v105, v37, s77
    v_perm_b32 v73, v109, v41, s77
    v_perm_b32 v74, v113, v45, s77
    v_perm_b32 v75, v117, v49, s77
    v_add_u32 v27, 0x10000, v27
    buffer_store_dwordx4 v[72:75], v27, s[32:35], 0 offen sc1
    v_pk_fma_f32 v[106:107], v[106:107], s[76:77], v[10:11] op_sel_hi:[1,0,1]
    v_pk_fma_f32 v[110:111], v[110:111], s[76:77], v[10:11] op_sel_hi:[1,0,1]
    v_pk_fma_f32 v[114:115], v[114:115], s[76:77], v[10:11] op_sel_hi:[1,0,1]
    v_pk_fma_f32 v[118:119], v[118:119], s[76:77], v[10:11] op_sel_hi:[1,0,1]
    v_pk_add_f32 v[42:43], v[42:43], s[68:69]
    v_pk_add_f32 v[50:51], v[50:51], s[68:69]
    v_lshl_add_u64 v[106:107], v[106:107], 0, s[80:81]
    v_lshl_add_u64 v[110:111], v[110:111], 0, s[80:81]
    v_lshl_add_u64 v[114:115], v[114:115], 0, s[80:81]
    v_lshl_add_u64 v[118:119], v[118:119], 0, s[80:81]
    v_lshl_add_u64 v[38:39], v[38:39], 0, s[80:81]
    v_lshl_add_u64 v[42:43], v[42:43], 0, s[80:81]
    v_lshl_add_u64 v[46:47], v[46:47], 0, s[80:81]
    v_lshl_add_u64 v[50:51], v[50:51], 0, s[80:81]
    v_sub_u32_sdwa v106, v106, v38 clamp dst_sel:DWORD dst_unused:UNUSED_PAD src0_sel:DWORD src1_sel:WORD_1
    v_sub_u32_sdwa v114, v114, v46 clamp dst_sel:DWORD dst_unused:UNUSED_PAD src0_sel:DWORD src1_sel:WORD_1
    v_sub_u32_sdwa v42, v42, v106 clamp dst_sel:DWORD dst_unused:UNUSED_PAD src0_sel:DWORD src1_sel:WORD_1
    v_sub_u32_sdwa v50, v50, v114 clamp dst_sel:DWORD dst_unused:UNUSED_PAD src0_sel:DWORD src1_sel:WORD_1
    v_sub_u32_sdwa v110, v110, v42 clamp dst_sel:DWORD dst_unused:UNUSED_PAD src0_sel:DWORD src1_sel:WORD_1
    v_sub_u32_sdwa v118, v118, v50 clamp dst_sel:DWORD dst_unused:UNUSED_PAD src0_sel:DWORD src1_sel:WORD_1
    v_perm_b32 v76, v106, v38, s77
    v_perm_b32 v77, v110, v42, s77
    v_perm_b32 v78, v114, v46, s77
    v_perm_b32 v79, v118, v50, s77
    v_add_u32 v27, 0x10000, v27
    buffer_store_dwordx4 v[76:79], v27, s[32:35], 0 offen sc1
    v_sub_u32_sdwa v107, v107, v39 clamp dst_sel:DWORD dst_unused:UNUSED_PAD src0_sel:DWORD src1_sel:WORD_1
    v_sub_u32_sdwa v115, v115, v47 clamp dst_sel:DWORD dst_unused:UNUSED_PAD src0_sel:DWORD src1_sel:WORD_1
    v_sub_u32_sdwa v43, v43, v107 clamp dst_sel:DWORD dst_unused:UNUSED_PAD src0_sel:DWORD src1_sel:WORD_1
    v_sub_u32_sdwa v51, v51, v115 clamp dst_sel:DWORD dst_unused:UNUSED_PAD src0_sel:DWORD src1_sel:WORD_1
    v_sub_u32_sdwa v111, v111, v43 clamp dst_sel:DWORD dst_unused:UNUSED_PAD src0_sel:DWORD src1_sel:WORD_1
    v_sub_u32_sdwa v119, v119, v51 clamp dst_sel:DWORD dst_unused:UNUSED_PAD src0_sel:DWORD src1_sel:WORD_1
    v_perm_b32 v80, v107, v39, s77
    v_perm_b32 v81, v111, v43, s77
    v_perm_b32 v82, v115, v47, s77
    v_perm_b32 v83, v119, v51, s77
    v_add_u32 v27, 0x10000, v27
    buffer_store_dwordx4 v[80:83], v27, s[32:35], 0 offen sc1
G_BVD:
    s_waitcnt vmcnt(4)
    s_branch G_DONE
G_T3:
    s_cmp_eq_u32 s2, 212
    s_cbranch_scc0 G_NODUM
    v_mov_b32 v68, 0x7f000000
    v_mov_b32 v69, 0x7f000000
    v_mov_b32 v70, 0x7f000000
    v_mov_b32 v71, 0x7f000000
G_NODUM:
    buffer_store_dwordx4 v[68:71], v27, s[32:35], 0 offen sc1
    s_waitcnt vmcnt(5)
    s_mov_b64 exec, s[74:75]
    s_cbranch_execz G_NOBIN
    v_mov_b32 v126, v14
    v_mov_b32 v14, 21846
    s_mov_b32 s68, 1026762
    s_mov_b32 s69, 0x05040100
    s_mov_b32 s70, 0x07060100
    v_lshlrev_b32_sdwa v28, 2, v16 dst_sel:DWORD dst_unused:UNUSED_PAD src0_sel:DWORD src1_sel:BYTE_0
    ds_add_rtn_u32 v32, v28, v14 offset:8448
    v_lshlrev_b32_sdwa v29, 2, v17 dst_sel:DWORD dst_unused:UNUSED_PAD src0_sel:DWORD src1_sel:BYTE_0
    ds_add_rtn_u32 v33, v29, v14 offset:8448
    v_lshlrev_b32_sdwa v30, 2, v18 dst_sel:DWORD dst_unused:UNUSED_PAD src0_sel:DWORD src1_sel:BYTE_0
    ds_add_rtn_u32 v34, v30, v14 offset:8448
    v_lshlrev_b32_sdwa v31, 2, v19 dst_sel:DWORD dst_unused:UNUSED_PAD src0_sel:DWORD src1_sel:BYTE_0
    ds_add_rtn_u32 v35, v31, v14 offset:8448
    v_mul_u32_u24 v28, 68, v28
    v_lshrrev_b32 v16, 8, v16
    v_mul_u32_u24 v29, 68, v29
    v_lshrrev_b32 v17, 8, v17
    v_mul_u32_u24 v30, 68, v30
    v_lshrrev_b32 v18, 8, v18
    v_mul_u32_u24 v31, 68, v31
    v_lshrrev_b32 v19, 8, v19
    s_waitcnt lgkmcnt(3)
    v_min_u32 v32, s68, v32
    v_lshrrev_b32 v32, 14, v32
    v_lshl_add_u32 v36, v32, 2, v28
    v_and_b32 v32, 3, v32
    v_or3_b32 v32, v36, 12, v32
    ds_write_b8 v32, v16 offset:12544
    s_waitcnt lgkmcnt(3)
    v_min_u32 v33, s68, v33
    v_lshrrev_b32 v33, 14, v33
    v_lshl_add_u32 v37, v33, 2, v29
    v_and_b32 v33, 3, v33
    v_or3_b32 v33, v37, 12, v33
    ds_write_b8 v33, v17 offset:12544
    s_waitcnt lgkmcnt(3)
    v_min_u32 v34, s68, v34
    v_lshrrev_b32 v34, 14, v34
    v_lshl_add_u32 v38, v34, 2, v30
    v_and_b32 v34, 3, v34
    v_or3_b32 v34, v38, 12, v34
    ds_write_b8 v34, v18 offset:12544
    s_waitcnt lgkmcnt(3)
    v_min_u32 v35, s68, v35
    v_lshrrev_b32 v35, 14, v35
    v_lshl_add_u32 v39, v35, 2, v31
    v_and_b32 v35, 3, v35
    v_or3_b32 v35, v39, 12, v35
    ds_write_b8 v35, v19 offset:12544
    v_perm_b32 v20, v24, v20, s69
    ds_write_b32 v36, v20 offset:12544
    v_perm_b32 v21, v24, v21, s70
    ds_write_b32 v37, v21 offset:12544
    v_perm_b32 v22, v25, v22, s69
    ds_write_b32 v38, v22 offset:12544
    v_perm_b32 v23, v25, v23, s70
    ds_write_b32 v39, v23 offset:12544
    v_mov_b32 v14, v126
G_NOBIN:
    s_mov_b64 exec, -1
    ds_read_b128 v[28:31], v8
    ds_read_b128 v[32:35], v9
    s_waitcnt vmcnt(1)
G_DONE:
A_JOIN:
    s_setprio 3
    s_waitcnt lgkmcnt(0)
    s_barrier
    ds_read_b64 v[122:123], v1 offset:9744
    ds_read2st64_b32 v[8:9], v5 offset0:33 offset1:35
    ds_read_b128 v[68:71], v4 offset:12544
    ds_read_b128 v[72:75], v4 offset:47360
    s_waitcnt lgkmcnt(2)
    v_cmp_le_u32 s[72:73], v102, v8
    v_cmp_le_u32 s[74:75], v102, v9
    v_max_u32 v10, v8, v9
    v_cmp_le_u32 vcc, s39, v10
    s_cmp_ge_u32 s3, 12
    s_waitcnt lgkmcnt(1)
    v_bfi_b32 v68, s40, v122, v68
    v_bfi_b32 v69, s40, v122, v69
    v_bfi_b32 v70, s40, v122, v70
    v_or_b32 v71, v123, v71
    s_cbranch_scc1 A_GL1
    s_mov_b64 exec, s[72:73]
    global_store_dwordx4 v6, v[68:71], s[26:27] sc1
    s_mov_b64 exec, -1
A_GL1:
    s_waitcnt lgkmcnt(0)
    v_bfi_b32 v72, s40, v122, v72
    v_bfi_b32 v73, s40, v122, v73
    v_bfi_b32 v74, s40, v122, v74
    v_or_b32 v75, v123, v75
    s_cbranch_scc1 A_GL2
    s_mov_b64 exec, s[74:75]
    global_store_dwordx4 v7, v[72:75], s[26:27] sc1
A_GL2:
    s_cbranch_vccnz R_PUB2
A_PUBD:
    s_mov_b64 exec, -1
    s_setprio 0
    s_cmp_ge_u32 s3, 12
    s_cbranch_scc0 B_NOAU
    s_mov_b32 s84, s66
    s_setprio 1
    ds_read_b64_tr_b16 v[36:37], v12 offset:16384
    ds_read_b64_tr_b16 v[38:39], v12 offset:16896
    ds_read_b64_tr_b16 v[40:41], v12 offset:17408
    ds_read_b64_tr_b16 v[42:43], v12 offset:17920
    ds_read_b64_tr_b16 v[44:45], v13 offset:16384
    ds_read_b64_tr_b16 v[46:47], v13 offset:16896
    ds_read_b64_tr_b16 v[48:49], v13 offset:17408
    ds_read_b64_tr_b16 v[50:51], v13 offset:17920
    ds_read_b64_tr_b16 v[84:85], v14 offset:16384
    ds_read_b64_tr_b16 v[86:87], v14 offset:16896
    ds_read_b64_tr_b16 v[88:89], v14 offset:17408
    ds_read_b64_tr_b16 v[90:91], v14 offset:17920
    ds_read_b64_tr_b16 v[92:93], v15 offset:16384
    ds_read_b64_tr_b16 v[94:95], v15 offset:16896
    ds_read_b64_tr_b16 v[96:97], v15 offset:17408
    ds_read_b64_tr_b16 v[98:99], v15 offset:17920
    s_waitcnt lgkmcnt(12)
    v_mfma_f32_16x16x32_bf16 v[104:107], v[28:31], v[36:39], 0
    v_mfma_f32_16x16x32_bf16 v[104:107], v[32:35], v[40:43], v[104:107]
    s_waitcnt lgkmcnt(8)
    v_mfma_f32_16x16x32_bf16 v[108:111], v[28:31], v[44:47], 0
    v_mfma_f32_16x16x32_bf16 v[108:111], v[32:35], v[48:51], v[108:111]
    s_waitcnt lgkmcnt(4)
    v_mfma_f32_16x16x32_bf16 v[112:115], v[28:31], v[84:87], 0
    v_mfma_f32_16x16x32_bf16 v[112:115], v[32:35], v[88:91], v[112:115]
    s_waitcnt lgkmcnt(0)
    v_mfma_f32_16x16x32_bf16 v[116:119], v[28:31], v[92:95], 0
    v_mfma_f32_16x16x32_bf16 v[116:119], v[32:35], v[96:99], v[116:119]
    s_waitcnt vmcnt(0)
    s_mov_b64 exec, s[72:73]
    global_store_dwordx4 v6, v[68:71], s[26:27] sc1
    s_mov_b64 exec, s[74:75]
    global_store_dwordx4 v7, v[72:75], s[26:27] sc1
    s_mov_b64 exec, -1
    s_lshl_b32 s64, s2, 2
    s_add_u32 s64, s64, s84
    s_lshl_b32 s64, s64, 2
    s_add_u32 s64, s64, 0x390000
    s_sub_u32 s64, s64, s38
    v_mov_b32 v26, s64
    v_xor_b32 v25, s48, v123
    s_mov_b64 exec, 1
    global_store_dword v26, v25, s[26:27] sc1
    s_mov_b64 exec, -1
    ds_read_b64_tr_b16 v[36:37], v12 offset:24576
    ds_read_b64_tr_b16 v[38:39], v12 offset:25088
    ds_read_b64_tr_b16 v[40:41], v12 offset:25600
    ds_read_b64_tr_b16 v[42:43], v12 offset:26112
    ds_read_b64_tr_b16 v[44:45], v13 offset:24576
    ds_read_b64_tr_b16 v[46:47], v13 offset:25088
    ds_read_b64_tr_b16 v[48:49], v13 offset:25600
    ds_read_b64_tr_b16 v[50:51], v13 offset:26112
    ds_read_b64_tr_b16 v[84:85], v14 offset:24576
    ds_read_b64_tr_b16 v[86:87], v14 offset:25088
    ds_read_b64_tr_b16 v[88:89], v14 offset:25600
    ds_read_b64_tr_b16 v[90:91], v14 offset:26112
    ds_read_b64_tr_b16 v[92:93], v15 offset:24576
    ds_read_b64_tr_b16 v[94:95], v15 offset:25088
    ds_read_b64_tr_b16 v[96:97], v15 offset:25600
    ds_read_b64_tr_b16 v[98:99], v15 offset:26112
    s_waitcnt lgkmcnt(12)
    v_mfma_f32_16x16x32_bf16 v[52:55], v[36:39], v[28:31], 0
    v_mfma_f32_16x16x32_bf16 v[52:55], v[40:43], v[32:35], v[52:55]
    s_waitcnt lgkmcnt(8)
    v_mfma_f32_16x16x32_bf16 v[56:59], v[44:47], v[28:31], 0
    v_mfma_f32_16x16x32_bf16 v[56:59], v[48:51], v[32:35], v[56:59]
    s_waitcnt lgkmcnt(4)
    v_mfma_f32_16x16x32_bf16 v[60:63], v[84:87], v[28:31], 0
    v_mfma_f32_16x16x32_bf16 v[60:63], v[88:91], v[32:35], v[60:63]
    s_waitcnt lgkmcnt(0)
    v_mfma_f32_16x16x32_bf16 v[64:67], v[92:95], v[28:31], 0
    v_mfma_f32_16x16x32_bf16 v[64:67], v[96:99], v[32:35], v[64:67]
    s_mul_i32 s65, s66, 12800
    s_add_u32 s65, s65, 82176
    v_mul_u32_u24 v26, 3200, v125
    v_lshl_add_u32 v26, v124, 4, v26
    v_add_u32 v25, s65, v26
    v_mul_u32_u24 v27, 800, v124
    v_lshl_add_u32 v27, v125, 4, v27
    v_add_u32 v27, s65, v27
    v_mul_f32 v104, s76, v104
    v_mul_f32 v105, s76, v105
    v_mul_f32 v106, s76, v106
    v_mul_f32 v107, s76, v107
    v_mul_f32 v108, s76, v108
    v_mul_f32 v109, s76, v109
    v_mul_f32 v110, s76, v110
    v_mul_f32 v111, s76, v111
    v_mul_f32 v112, s76, v112
    v_mul_f32 v113, s76, v113
    v_mul_f32 v114, s76, v114
    v_mul_f32 v115, s76, v115
    v_mul_f32 v116, s76, v116
    v_mul_f32 v117, s76, v117
    v_mul_f32 v118, s76, v118
    v_mul_f32 v119, s76, v119
    s_cmp_eq_u32 s3, 12
    s_cselect_b32 exec_lo, 0x000f000f, -1
    s_cselect_b32 exec_hi, 0x000f000f, -1
    ds_write_b128 v27, v[52:55] offset:256
    ds_write_b128 v27, v[56:59] offset:320
    ds_write_b128 v27, v[60:63] offset:384
    ds_write_b128 v27, v[64:67] offset:448
    s_cselect_b32 exec_hi, 0, -1
    s_cselect_b32 exec_lo, 0xffff, -1
    v_max3_f32 v26, |v104|, |v105|, |v106|
    v_max3_f32 v26, |v107|, |v108|, v26
    v_max3_f32 v26, |v109|, |v110|, v26
    v_max3_f32 v26, |v111|, |v112|, v26
    v_max3_f32 v26, |v113|, |v114|, v26
    v_max3_f32 v26, |v115|, |v116|, v26
    v_max3_f32 v26, |v117|, |v118|, v26
    v_max_f32 v26, |v119|, v26
    v_cmp_nge_f32 vcc, 0x427c0000, v26
    v_add_f32 v36, 0xc2780000, v104
    v_add_f32 v37, 0xc2780000, v108
    v_add_f32 v38, 0xc2780000, v112
    v_add_f32 v39, 0xc2780000, v116
    ds_write_b32 v25, v104 offset:512
    v_exp_f32 v36, v36
    ds_write_b32 v25, v108 offset:516
    v_exp_f32 v37, v37
    ds_write_b32 v25, v112 offset:520
    v_exp_f32 v38, v38
    ds_write_b32 v25, v116 offset:524
    v_exp_f32 v39, v39
    s_nop 0
    ds_write_b128 v25, v[36:39] offset:0
    s_cbranch_scc1 G_EAD
    v_add_f32 v40, 0xc2780000, v105
    v_add_f32 v41, 0xc2780000, v109
    v_add_f32 v42, 0xc2780000, v113
    v_add_f32 v43, 0xc2780000, v117
    ds_write_b32 v25, v105 offset:1312
    v_exp_f32 v40, v40
    ds_write_b32 v25, v109 offset:1316
    v_exp_f32 v41, v41
    ds_write_b32 v25, v113 offset:1320
    v_exp_f32 v42, v42
    ds_write_b32 v25, v117 offset:1324
    v_exp_f32 v43, v43
    s_nop 0
    ds_write_b128 v25, v[40:43] offset:800
    v_add_f32 v44, 0xc2780000, v106
    v_add_f32 v45, 0xc2780000, v110
    v_add_f32 v46, 0xc2780000, v114
    v_add_f32 v47, 0xc2780000, v118
    ds_write_b32 v25, v106 offset:2112
    v_exp_f32 v44, v44
    ds_write_b32 v25, v110 offset:2116
    v_exp_f32 v45, v45
    ds_write_b32 v25, v114 offset:2120
    v_exp_f32 v46, v46
    ds_write_b32 v25, v118 offset:2124
    v_exp_f32 v47, v47
    s_nop 0
    ds_write_b128 v25, v[44:47] offset:1600
    v_add_f32 v48, 0xc2780000, v107
    v_add_f32 v49, 0xc2780000, v111
    v_add_f32 v50, 0xc2780000, v115
    v_add_f32 v51, 0xc2780000, v119
    ds_write_b32 v25, v107 offset:2912
    v_exp_f32 v48, v48
    ds_write_b32 v25, v111 offset:2916
    v_exp_f32 v49, v49
    ds_write_b32 v25, v115 offset:2920
    v_exp_f32 v50, v50
    ds_write_b32 v25, v119 offset:2924
    v_exp_f32 v51, v51
    s_nop 0
    ds_write_b128 v25, v[48:51] offset:2400
G_EAD:
    s_mov_b64 exec, -1
    s_cmp_lg_u64 vcc, 0
    s_cselect_b32 s79, 1, 0
    s_branch B_CONST
B_NOAU:
    s_waitcnt vmcnt(0)
B_CONST:
    s_mov_b32 s28, s26
    s_or_b32 s29, s27, 0x1000000
    v_and_b32 v5, 63, v0
    s_cmp_lt_u32 s2, 212
    s_cselect_b32 s64, 49, 48
    v_cmp_gt_u32 s[82:83], s64, v5
    v_lshlrev_b32 v5, 2, v5
    v_and_b32 v4, 15, v0
    v_lshlrev_b32 v6, 1, v4
    ds_read_u16 v16, v6 offset:8192
    ds_read_u16 v17, v6 offset:8224
    ds_read_u16 v18, v6 offset:8256
    ds_read_u16 v19, v6 offset:8288
    v_lshlrev_b32 v4, 4, v4
    v_mov_b32 v31, 4
    v_mov_b32 v30, 196608
    v_mov_b32 v97, v4
    v_mov_b32 v99, v4
    v_mov_b32 v105, v4
    v_mov_b32 v107, v4
    v_lshlrev_b32 v118, 1, v6
    v_mov_b32 v119, v4
    v_lshrrev_b32 v7, 4, v0
    v_mul_u32_u24 v117, 800, v7
    s_mov_b32 s64, 82432
    v_add3_u32 v117, v117, s64, v4
    v_lshlrev_b32 v8, 2, v6
    v_and_b32 v9, 0x70, v0
    v_xor_b32 v9, v8, v9
    v_lshl_add_u32 v9, v7, 7, v9
    ds_read_b64 v[114:115], v9 offset:0
    v_lshl_add_u32 v116, v7, 15, v8
    s_lshl_b32 s64, s2, 7
    v_add_u32 v116, s64, v116
    s_mov_b64 s[32:33], s[22:23]
    s_mov_b32 s34, 0x186a00
    s_mov_b32 s35, 0x20000
    v_mov_b64 v[100:101], 0
    v_mov_b64 v[20:21], 0
    v_mov_b64 v[44:45], 0
    v_mov_b64 v[102:103], 0
    v_mov_b64 v[22:23], 0
    v_mov_b64 v[46:47], 0
    s_mov_b64 s[68:69], -1
    s_mov_b64 s[70:71], -1
    s_cmp_lt_u32 s3, 4
    s_cselect_b32 s78, 2, 0
    s_mov_b32 s16, 0x20800000
    s_mov_b32 s17, s16
    s_mov_b32 s18, 0x548637bd
    s_mov_b32 s19, s18
    s_mov_b32 s20, 32
    s_mov_b32 s21, 32
    s_mov_b32 s24, 512
    s_mov_b32 s25, 800
    s_mov_b32 s85, 123776
    s_mov_b32 s56, 0x11111111
    s_mov_b32 s57, s56
    s_lshl_b64 s[58:59], s[56:57], 1
    s_lshl_b64 s[60:61], s[56:57], 2
    s_lshl_b64 s[62:63], s[56:57], 3
    v_bfe_u32 v124, v0, 4, 2
    v_bfe_u32 v125, v0, 5, 1
    v_bfe_u32 v126, v0, 2, 1
    v_lshl_add_u32 v125, v126, 1, v125
    v_bfe_u32 v126, v0, 3, 2
    v_lshlrev_b32 v126, 2, v126
    v_bfe_u32 v34, v0, 2, 3
    s_lshl_b32 s64, s3, 3
    s_sub_u32 s64, s2, s64
    v_sub_u32 v34, s64, v34
    v_and_b32 v34, 127, v34
    v_and_b32 v35, 32, v0
    v_lshl_add_u32 v34, v35, 2, v34
    v_and_b32 v35, 3, v0
    v_lshlrev_b32 v33, 8, v34
    v_and_b32 v32, 1, v35
    v_lshl_add_u32 v33, v32, 7, v33
    v_lshrrev_b32 v32, 1, v35
    v_lshl_add_u32 v33, v32, 16, v33
    s_sub_u32 s64, s3, 13
    s_lshl_b32 s64, s64, 20
    s_lshr_b32 s65, s2, 7
    s_lshl_b32 s65, s65, 19
    s_add_u32 s64, s64, s65
    v_add_u32 v33, s64, v33
    v_lshlrev_b32 v34, 4, v34
    v_lshl_add_u32 v34, v35, 2, v34
    s_sub_u32 s64, 0x390000, s38
    v_add_u32 v34, s64, v34
    s_mov_b32 s64, 0xbfb8aa3b
    s_mov_b32 s66, 0x0000ffff
    s_mov_b32 s67, 0xffff0000
    s_waitcnt lgkmcnt(0)
    v_lshlrev_b32 v16, 16, v16
    v_lshlrev_b32 v17, 16, v17
    v_lshlrev_b32 v18, 16, v18
    v_lshlrev_b32 v19, 16, v19
    v_mul_f32 v16, s64, v16
    v_mul_f32 v17, s64, v17
    v_mul_f32 v18, s64, v18
    v_mul_f32 v19, s64, v19
    v_cvt_pk_bf16_f32 v16, 0, v16
    v_cvt_pk_bf16_f32 v17, 0, v17
    v_cvt_pk_bf16_f32 v18, 0, v18
    v_cvt_pk_bf16_f32 v19, 0, v19
    v_cndmask_b32 v16, 0, v16, s[66:67]
    v_cndmask_b32 v17, 0, v17, s[66:67]
    v_cndmask_b32 v18, 0, v18, s[66:67]
    v_cndmask_b32 v19, 0, v19, s[66:67]
    v_lshlrev_b32 v112, 16, v114
    v_and_b32 v113, 0xffff0000, v114
    v_lshlrev_b32 v114, 16, v115
    v_and_b32 v115, 0xffff0000, v115
    s_setprio 0
    s_waitcnt vmcnt(1)
    s_cmp_ge_u32 s3, 12
    s_cbranch_scc1 B_DRD
    s_waitcnt vmcnt(0)
B_DRD:
    global_load_dwordx4 v[8:11], v2, s[26:27] sc1
    global_load_dwordx4 v[12:15], v3, s[26:27] sc1
B_P0:
    s_waitcnt vmcnt(0)
    s_mov_b64 exec, s[68:69]
    v_xor_b32 v8, v122, v8
    v_xor_b32 v9, v122, v9
    v_xor_b32 v10, v122, v10
    v_xor_b32 v11, v123, v11
    s_mov_b64 exec, s[70:71]
    v_xor_b32 v12, v122, v12
    v_xor_b32 v13, v122, v13
    v_xor_b32 v14, v122, v14
    v_xor_b32 v15, v123, v15
    s_mov_b64 exec, -1
    v_or3_b32 v6, v8, v9, v10
    v_and_b32 v6, s40, v6
    v_and_or_b32 v6, v11, s41, v6
    v_cmp_ne_u32 s[68:69], 0, v6
    v_cmp_gt_u32 s[64:65], s42, v11
    v_or3_b32 v7, v12, v13, v14
    v_and_b32 v7, s40, v7
    v_and_or_b32 v7, v15, s41, v7
    v_cmp_ne_u32 s[70:71], 0, v7
    v_cmp_gt_u32 s[66:67], s42, v15
    s_andn2_b64 s[64:65], s[64:65], s[68:69]
    s_lshl_b64 s[74:75], s[64:65], 1
    s_or_b64 s[74:75], s[74:75], s[36:37]
    s_andn2_b64 s[66:67], s[66:67], s[70:71]
    s_lshl_b64 s[76:77], s[66:67], 1
    s_or_b64 s[76:77], s[76:77], s[36:37]
    s_and_b64 s[72:73], s[68:69], s[74:75]
    s_and_b64 s[80:81], s[70:71], s[76:77]
    s_or_b64 s[72:73], s[72:73], s[80:81]
    s_cbranch_scc1 B_P0_RETRY
    v_lshlrev_b32_sdwa v24, 2, v11 dst_sel:DWORD dst_unused:UNUSED_PAD src0_sel:DWORD src1_sel:BYTE_0
    v_lshlrev_b32_sdwa v25, 2, v11 dst_sel:DWORD dst_unused:UNUSED_PAD src0_sel:DWORD src1_sel:BYTE_1
    v_lshlrev_b32_sdwa v26, 2, v11 dst_sel:DWORD dst_unused:UNUSED_PAD src0_sel:DWORD src1_sel:BYTE_2
    v_lshlrev_b32_sdwa v27, 2, v15 dst_sel:DWORD dst_unused:UNUSED_PAD src0_sel:DWORD src1_sel:BYTE_0
    v_lshlrev_b32_sdwa v28, 2, v15 dst_sel:DWORD dst_unused:UNUSED_PAD src0_sel:DWORD src1_sel:BYTE_1
    v_lshlrev_b32_sdwa v29, 2, v15 dst_sel:DWORD dst_unused:UNUSED_PAD src0_sel:DWORD src1_sel:BYTE_2
    s_mov_b64 exec, s[74:75]
    v_cmp_gt_u32_sdwa s[44:45], 49, v11 src0_sel:DWORD src1_sel:BYTE_0
    v_cmp_gt_u32_sdwa s[46:47], 49, v11 src0_sel:DWORD src1_sel:BYTE_1
    v_cmp_gt_u32_sdwa s[48:49], 49, v11 src0_sel:DWORD src1_sel:BYTE_2
    s_mov_b64 exec, s[44:45]
    ds_add_rtn_u32 v36, v24, v31 offset:9472
    s_mov_b64 exec, s[46:47]
    ds_add_rtn_u32 v37, v25, v31 offset:9472
    s_mov_b64 exec, s[48:49]
    ds_add_rtn_u32 v38, v26, v31 offset:9472
    s_mov_b64 exec, s[76:77]
    v_cmp_gt_u32_sdwa s[50:51], 49, v15 src0_sel:DWORD src1_sel:BYTE_0
    v_cmp_gt_u32_sdwa s[52:53], 49, v15 src0_sel:DWORD src1_sel:BYTE_1
    v_cmp_gt_u32_sdwa s[54:55], 49, v15 src0_sel:DWORD src1_sel:BYTE_2
    s_mov_b64 exec, s[50:51]
    ds_add_rtn_u32 v39, v27, v31 offset:9472
    s_mov_b64 exec, s[52:53]
    ds_add_rtn_u32 v40, v28, v31 offset:9472
    s_mov_b64 exec, s[54:55]
    ds_add_rtn_u32 v41, v29, v31 offset:9472
    s_mov_b64 exec, -1
    s_and_b64 s[64:65], s[64:65], s[74:75]
    s_and_b64 s[66:67], s[66:67], s[76:77]
    s_or_b64 s[72:73], s[64:65], s[66:67]
    s_or_b32 s72, s72, s73
    s_and_b32 s72, s72, 0x80808080
    s_or_b32 s72, s72, s79
    s_cbranch_scc1 R_MORE
B_RDONE:
    s_waitcnt lgkmcnt(0)
    s_barrier
    ds_read_b32 v6, v5 offset:9472
    global_load_dword v35, v34, s[26:27] sc1
    s_waitcnt lgkmcnt(0)
    v_add_u32 v2, 7, v6
    v_and_b32 v2, -8, v2
    v_max_u32 v2, 8, v2
    v_cndmask_b32 v2, 0, v2, s[82:83]
    s_cmp_ge_u32 s3, 13
    s_cbranch_scc0 B_NOPF5
    global_load_dword v84, v33, s[26:27] sc1
B_NOPF5:
    v_mov_b32 v3, v2
    s_nop 1
    v_add_u32_dpp v3, v3, v3 row_shr:1 row_mask:0xf bank_mask:0xf
    s_nop 1
    v_add_u32_dpp v3, v3, v3 row_shr:2 row_mask:0xf bank_mask:0xf
    s_nop 1
    v_add_u32_dpp v3, v3, v3 row_shr:4 row_mask:0xf bank_mask:0xf
    s_nop 1
    v_add_u32_dpp v3, v3, v3 row_shr:8 row_mask:0xf bank_mask:0xf
    s_nop 1
    v_add_u32_dpp v3, v3, v3 row_bcast:15 row_mask:0xa bank_mask:0xf
    s_nop 1
    v_add_u32_dpp v3, v3, v3 row_bcast:31 row_mask:0xc bank_mask:0xf
    v_sub_u32 v7, v3, v2
    ds_write_b32 v5, v7 offset:9984
    v_readlane_b32 s64, v3, 63
    ds_read_b32 v24, v24 offset:9984
    ds_read_b32 v25, v25 offset:9984
    ds_read_b32 v26, v26 offset:9984
    ds_read_b32 v27, v27 offset:9984
    ds_read_b32 v28, v28 offset:9984
    ds_read_b32 v29, v29 offset:9984
    s_add_u32 s65, s64, 31
    s_lshr_b32 s66, s65, 9
    s_bfe_u32 s67, s65, 0x40005
    s_mul_i32 s68, s66, s3
    s_min_u32 s69, s67, s3
    s_add_u32 s68, s68, s69
    s_lshl_b32 s68, s68, 5
    s_cmp_lt_u32 s3, s67
    s_addc_u32 s72, s66, 0
    s_lshl_b32 s69, s72, 3
    s_add_u32 s70, s68, s85
    s_waitcnt lgkmcnt(3)
    v_add3_u32 v24, v24, v36, s85
    v_add3_u32 v25, v25, v37, s85
    v_add3_u32 v26, v26, v38, s85
    s_waitcnt lgkmcnt(0)
    v_add3_u32 v27, v27, v39, s85
    v_add3_u32 v28, v28, v40, s85
    v_add3_u32 v29, v29, v41, s85
    s_mov_b64 exec, s[44:45]
    ds_write_b32 v24, v8
    s_mov_b64 exec, s[46:47]
    ds_write_b32 v25, v9
    s_mov_b64 exec, s[48:49]
    ds_write_b32 v26, v10
    s_mov_b64 exec, s[50:51]
    ds_write_b32 v27, v12
    s_mov_b64 exec, s[52:53]
    ds_write_b32 v28, v13
    s_mov_b64 exec, s[54:55]
    ds_write_b32 v29, v14
    s_mov_b64 exec, -1
    v_mul_u32_u24 v42, s69, v124
    v_mul_u32_u24 v43, s69, v125
    v_add_u32 v42, s70, v42
    v_add3_u32 v43, v43, s70, v126
    s_waitcnt vmcnt(1)
    s_cmp_ge_u32 s3, 13
    s_cbranch_scc1 B_FLW
    s_waitcnt vmcnt(0)
B_FLW:
    v_cmp_ne_u32 vcc, v123, v35
    s_cmp_lg_u32 s78, 0
    s_cbranch_scc1 R_EXTRA
B_XDONE:
    s_cbranch_vccnz R_FLAGS
B_FDONE:
    s_waitcnt lgkmcnt(0)
    s_barrier
    ds_read_u16 v96, v42 offset:0
    ds_read_u16 v98, v42 offset:4
    ds_read_u16 v104, v42 offset:8
    ds_read_u16 v106, v42 offset:12
    v_and_b32 v9, 0x3f0, v0
    ds_read_b128 v[32:35], v9 offset:10496
    ds_read_b32 v8, v1 offset:9728
    s_setprio 3
    s_waitcnt lgkmcnt(2)
    buffer_load_dwordx4 v[48:51], v[96:97], s[28:31], 0 idxen offen sc1
    buffer_load_dwordx4 v[52:55], v[98:99], s[28:31], 0 idxen offen sc1
    buffer_load_dwordx4 v[56:59], v[104:105], s[28:31], 0 idxen offen sc1
    buffer_load_dwordx4 v[60:63], v[106:107], s[28:31], 0 idxen offen sc1
    ds_read_u16 v96, v42 offset:16
    ds_read_u16 v98, v42 offset:20
    ds_read_u16 v104, v42 offset:24
    ds_read_u16 v106, v42 offset:28
    ds_read_b128 v[120:123], v9 offset:11520
    ds_read_b128 v[108:111], v117
    s_waitcnt lgkmcnt(6)
    v_readfirstlane_b32 s80, v8
    v_lshl_add_u64 v[32:33], v[32:33], 0, v[118:119]
    ds_read_b128 v[12:15], v33
    v_readlane_b32 s44, v34, 0
    v_readlane_b32 s45, v34, 16
    v_readlane_b32 s46, v34, 32
    v_readlane_b32 s47, v34, 48
    s_cmp_gt_u32 s64, 15872
    s_cselect_b32 s81, 1, 0
    s_or_b32 s80, s80, s81
    s_cbranch_scc1 K_SLOW
    s_mov_b64 exec, s[56:57]
    ds_read_b32 v100, v43 offset:0
    s_mov_b64 exec, s[58:59]
    ds_read_b32 v101, v43 offset:0
    s_mov_b64 exec, s[60:61]
    ds_read_b32 v102, v43 offset:0
    s_mov_b64 exec, s[62:63]
    ds_read_b32 v103, v43 offset:0
    s_mov_b64 exec, -1
    s_bitset1_b32 s44, s72
    s_bitset1_b32 s45, s72
    s_bitset1_b32 s46, s72
    s_bitset1_b32 s47, s72
    s_or_b32 s82, s44, s45
    s_or_b32 s83, s46, s47
    s_or_b32 s82, s82, s83
    s_lshl_b32 s81, 1, s72
    s_lshr_b32 s80, s81, 8
    s_or_b32 s82, s82, s80
    s_lshr_b32 s80, s81, 3
    s_or_b32 s82, s82, s80
    s_lshr_b32 s80, s81, 1
    s_or_b32 s82, s82, s80
    s_bfm_b32 s83, s72, 0
    s_lshr_b32 s83, s83, 4
    s_mov_b32 s73, 0
    s_waitcnt lgkmcnt(5)
    buffer_load_dwordx4 v[64:67], v[96:97], s[28:31], 0 idxen offen sc1
    buffer_load_dwordx4 v[68:71], v[98:99], s[28:31], 0 idxen offen sc1
    buffer_load_dwordx4 v[72:75], v[104:105], s[28:31], 0 idxen offen sc1
    buffer_load_dwordx4 v[76:79], v[106:107], s[28:31], 0 idxen offen sc1
    ds_read_u16 v96, v42 offset:32
    ds_read_u16 v98, v42 offset:36
    ds_read_u16 v104, v42 offset:40
    ds_read_u16 v106, v42 offset:44
    v_add_u32 v120, v120, v4
    v_add_u32 v121, v121, v4
    v_add_u32 v122, v122, v4
    v_cmp_lt_i32 s[48:49], 2, v123
    s_cmp_eq_u32 s72, 0
    s_cbranch_scc1 K_JOIN
    s_waitcnt vmcnt(4) lgkmcnt(4)
    v_mfma_f32_32x32x16_bf16 v[80:95], v[100:103], v[16:19], v[48:63]
    s_mov_b64 exec, s[56:57]
    ds_read_b32 v100, v43 offset:16
    s_mov_b64 exec, s[58:59]
    ds_read_b32 v101, v43 offset:16
    s_mov_b64 exec, s[60:61]
    ds_read_b32 v102, v43 offset:16
    s_mov_b64 exec, s[62:63]
    ds_read_b32 v103, v43 offset:16
    s_mov_b64 exec, -1
    s_setprio 3
    s_nop 2
K_LOOP:
K_STEP0:
    v_exp_f32 v80, v80
    v_exp_f32 v81, v81
    v_exp_f32 v82, v82
    v_exp_f32 v83, v83
    v_exp_f32 v84, v84
    v_exp_f32 v85, v85
    v_exp_f32 v86, v86
    v_exp_f32 v87, v87
    v_lshlrev_b64 v[48:49], 16, v[48:49]
    v_lshlrev_b64 v[50:51], 16, v[50:51]
    v_lshlrev_b64 v[52:53], 16, v[52:53]
    v_lshlrev_b64 v[54:55], 16, v[54:55]
    v_pk_fma_f32 v[80:81], v[80:81], v[12:13], s[16:17] clamp
    v_pk_fma_f32 v[82:83], v[82:83], v[14:15], s[16:17] clamp
    v_pk_fma_f32 v[84:85], v[84:85], v[12:13], s[16:17] clamp
    v_pk_fma_f32 v[86:87], v[86:87], v[14:15], s[16:17] clamp
    v_pk_mul_f32 v[24:25], v[80:81], v[84:85]
    v_pk_mul_f32 v[26:27], v[82:83], v[86:87]
    v_pk_mul_f32 v[8:9], v[48:49], v[84:85]
    v_pk_mul_f32 v[10:11], v[50:51], v[86:87]
    v_pk_add_f32 v[36:37], v[80:81], v[84:85]
    v_pk_add_f32 v[38:39], v[82:83], v[86:87]
    v_pk_fma_f32 v[8:9], v[52:53], v[80:81], v[8:9]
    v_pk_fma_f32 v[10:11], v[54:55], v[82:83], v[10:11]
    s_bitcmp1_b32 s83, 0
    s_cselect_b32 s30, s30, 0
    s_waitcnt lgkmcnt(0)
    buffer_load_dwordx4 v[48:51], v[96:97], s[28:31], 0 idxen offen sc1
    buffer_load_dwordx4 v[52:55], v[98:99], s[28:31], 0 idxen offen sc1
    v_rcp_f32 v24, v24
    v_rcp_f32 v25, v25
    v_rcp_f32 v26, v26
    v_rcp_f32 v27, v27
    v_pk_fma_f32 v[44:45], v[8:9], v[24:25], v[44:45]
    v_pk_fma_f32 v[20:21], v[36:37], v[24:25], v[20:21]
    v_pk_fma_f32 v[46:47], v[10:11], v[26:27], v[46:47]
    v_pk_fma_f32 v[22:23], v[38:39], v[26:27], v[22:23]
    s_bitcmp1_b32 s82, 1
    s_cbranch_scc1 K_FLUSH0
K_BACK0:
K_STEP1:
    v_exp_f32 v88, v88
    v_exp_f32 v89, v89
    v_exp_f32 v90, v90
    v_exp_f32 v91, v91
    v_exp_f32 v92, v92
    v_exp_f32 v93, v93
    v_exp_f32 v94, v94
    v_exp_f32 v95, v95
    v_lshlrev_b64 v[56:57], 16, v[56:57]
    v_lshlrev_b64 v[58:59], 16, v[58:59]
    v_lshlrev_b64 v[60:61], 16, v[60:61]
    v_lshlrev_b64 v[62:63], 16, v[62:63]
    v_pk_fma_f32 v[88:89], v[88:89], v[12:13], s[16:17] clamp
    v_pk_fma_f32 v[90:91], v[90:91], v[14:15], s[16:17] clamp
    v_pk_fma_f32 v[92:93], v[92:93], v[12:13], s[16:17] clamp
    v_pk_fma_f32 v[94:95], v[94:95], v[14:15], s[16:17] clamp
    v_pk_mul_f32 v[24:25], v[88:89], v[92:93]
    v_pk_mul_f32 v[26:27], v[90:91], v[94:95]
    v_pk_mul_f32 v[8:9], v[56:57], v[92:93]
    v_pk_mul_f32 v[10:11], v[58:59], v[94:95]
    v_pk_add_f32 v[36:37], v[88:89], v[92:93]
    v_pk_add_f32 v[38:39], v[90:91], v[94:95]
    v_pk_fma_f32 v[8:9], v[60:61], v[88:89], v[8:9]
    v_pk_fma_f32 v[10:11], v[62:63], v[90:91], v[10:11]
    s_bitcmp1_b32 s83, 1
    s_cselect_b32 s30, s30, 0
    s_waitcnt vmcnt(2)
    v_mfma_f32_32x32x16_bf16 v[80:95], v[100:103], v[16:19], v[64:79]
    v_rcp_f32 v24, v24
    v_rcp_f32 v25, v25
    v_rcp_f32 v26, v26
    v_rcp_f32 v27, v27
    buffer_load_dwordx4 v[56:59], v[104:105], s[28:31], 0 idxen offen sc1
    buffer_load_dwordx4 v[60:63], v[106:107], s[28:31], 0 idxen offen sc1
    v_pk_fma_f32 v[44:45], v[8:9], v[24:25], v[44:45]
    v_pk_fma_f32 v[20:21], v[36:37], v[24:25], v[20:21]
    v_pk_fma_f32 v[46:47], v[10:11], v[26:27], v[46:47]
    v_pk_fma_f32 v[22:23], v[38:39], v[26:27], v[22:23]
    ds_read_u16 v96, v42 offset:48
    ds_read_u16 v98, v42 offset:52
    ds_read_u16 v104, v42 offset:56
    ds_read_u16 v106, v42 offset:60
    s_mov_b64 exec, s[56:57]
    ds_read_b32 v100, v43 offset:32
    s_mov_b64 exec, s[58:59]
    ds_read_b32 v101, v43 offset:32
    s_mov_b64 exec, s[60:61]
    ds_read_b32 v102, v43 offset:32
    s_mov_b64 exec, s[62:63]
    ds_read_b32 v103, v43 offset:32
    s_mov_b64 exec, -1
    s_bitcmp1_b32 s82, 2
    s_cbranch_scc1 K_FLUSH1
K_BACK1:
K_STEP2:
    v_exp_f32 v80, v80
    v_exp_f32 v81, v81
    v_exp_f32 v82, v82
    v_exp_f32 v83, v83
    v_exp_f32 v84, v84
    v_exp_f32 v85, v85
    v_exp_f32 v86, v86
    v_exp_f32 v87, v87
    v_lshlrev_b64 v[64:65], 16, v[64:65]
    v_lshlrev_b64 v[66:67], 16, v[66:67]
    v_lshlrev_b64 v[68:69], 16, v[68:69]
    v_lshlrev_b64 v[70:71], 16, v[70:71]
    v_pk_fma_f32 v[80:81], v[80:81], v[12:13], s[16:17] clamp
    v_pk_fma_f32 v[82:83], v[82:83], v[14:15], s[16:17] clamp
    v_pk_fma_f32 v[84:85], v[84:85], v[12:13], s[16:17] clamp
    v_pk_fma_f32 v[86:87], v[86:87], v[14:15], s[16:17] clamp
    v_pk_mul_f32 v[24:25], v[80:81], v[84:85]
    v_pk_mul_f32 v[26:27], v[82:83], v[86:87]
    v_pk_mul_f32 v[8:9], v[64:65], v[84:85]
    v_pk_mul_f32 v[10:11], v[66:67], v[86:87]
    v_pk_add_f32 v[36:37], v[80:81], v[84:85]
    v_pk_add_f32 v[38:39], v[82:83], v[86:87]
    v_pk_fma_f32 v[8:9], v[68:69], v[80:81], v[8:9]
    v_pk_fma_f32 v[10:11], v[70:71], v[82:83], v[10:11]
    s_bitcmp1_b32 s83, 2
    s_cselect_b32 s30, s30, 0
    s_waitcnt lgkmcnt(0)
    buffer_load_dwordx4 v[64:67], v[96:97], s[28:31], 0 idxen offen sc1
    buffer_load_dwordx4 v[68:71], v[98:99], s[28:31], 0 idxen offen sc1
    v_rcp_f32 v24, v24
    v_rcp_f32 v25, v25
    v_rcp_f32 v26, v26
    v_rcp_f32 v27, v27
    v_pk_fma_f32 v[44:45], v[8:9], v[24:25], v[44:45]
    v_pk_fma_f32 v[20:21], v[36:37], v[24:25], v[20:21]
    v_pk_fma_f32 v[46:47], v[10:11], v[26:27], v[46:47]
    v_pk_fma_f32 v[22:23], v[38:39], v[26:27], v[22:23]
    s_bitcmp1_b32 s82, 3
    s_cbranch_scc1 K_FLUSH2
K_BACK2:
K_STEP3:
    v_exp_f32 v88, v88
    v_exp_f32 v89, v89
    v_exp_f32 v90, v90
    v_exp_f32 v91, v91
    v_exp_f32 v92, v92
    v_exp_f32 v93, v93
    v_exp_f32 v94, v94
    v_exp_f32 v95, v95
    v_lshlrev_b64 v[72:73], 16, v[72:73]
    v_lshlrev_b64 v[74:75], 16, v[74:75]
    v_lshlrev_b64 v[76:77], 16, v[76:77]
    v_lshlrev_b64 v[78:79], 16, v[78:79]
    v_pk_fma_f32 v[88:89], v[88:89], v[12:13], s[16:17] clamp
    v_pk_fma_f32 v[90:91], v[90:91], v[14:15], s[16:17] clamp
    v_pk_fma_f32 v[92:93], v[92:93], v[12:13], s[16:17] clamp
    v_pk_fma_f32 v[94:95], v[94:95], v[14:15], s[16:17] clamp
    v_pk_mul_f32 v[24:25], v[88:89], v[92:93]
    v_pk_mul_f32 v[26:27], v[90:91], v[94:95]
    v_pk_mul_f32 v[8:9], v[72:73], v[92:93]
    v_pk_mul_f32 v[10:11], v[74:75], v[94:95]
    v_pk_add_f32 v[36:37], v[88:89], v[92:93]
    v_pk_add_f32 v[38:39], v[90:91], v[94:95]
    v_pk_fma_f32 v[8:9], v[76:77], v[88:89], v[8:9]
    v_pk_fma_f32 v[10:11], v[78:79], v[90:91], v[10:11]
    s_bitcmp1_b32 s83, 3
    s_cselect_b32 s30, s30, 0
    s_waitcnt vmcnt(2)
    v_mfma_f32_32x32x16_bf16 v[80:95], v[100:103], v[16:19], v[48:63]
    v_rcp_f32 v24, v24
    v_rcp_f32 v25, v25
    v_rcp_f32 v26, v26
    v_rcp_f32 v27, v27
    buffer_load_dwordx4 v[72:75], v[104:105], s[28:31], 0 idxen offen sc1
    buffer_load_dwordx4 v[76:79], v[106:107], s[28:31], 0 idxen offen sc1
    v_pk_fma_f32 v[44:45], v[8:9], v[24:25], v[44:45]
    v_pk_fma_f32 v[20:21], v[36:37], v[24:25], v[20:21]
    v_pk_fma_f32 v[46:47], v[10:11], v[26:27], v[46:47]
    v_pk_fma_f32 v[22:23], v[38:39], v[26:27], v[22:23]
    ds_read_u16 v96, v42 offset:64
    ds_read_u16 v98, v42 offset:68
    ds_read_u16 v104, v42 offset:72
    ds_read_u16 v106, v42 offset:76
    s_mov_b64 exec, s[56:57]
    ds_read_b32 v100, v43 offset:48
    s_mov_b64 exec, s[58:59]
    ds_read_b32 v101, v43 offset:48
    s_mov_b64 exec, s[60:61]
    ds_read_b32 v102, v43 offset:48
    s_mov_b64 exec, s[62:63]
    ds_read_b32 v103, v43 offset:48
    s_mov_b64 exec, -1
    s_bitcmp1_b32 s82, 4
    s_cbranch_scc1 K_FLUSH3
K_BACK3:
    v_lshl_add_u64 v[42:43], v[42:43], 0, s[20:21]
    s_lshr_b32 s82, s82, 4
    s_lshr_b32 s83, s83, 4
    s_add_u32 s73, s73, 4
    s_branch K_LOOP
K_FLUSH0:
    s_add_u32 s74, s73, 1
    s_bitcmp1_b32 s44, s74
    s_cselect_b32 s75, 0xffff, 0
    s_bitcmp1_b32 s45, s74
    s_cselect_b32 s80, 0xffff0000, 0
    s_or_b32 exec_lo, s75, s80
    s_bitcmp1_b32 s46, s74
    s_cselect_b32 s75, 0xffff, 0
    s_bitcmp1_b32 s47, s74
    s_cselect_b32 s80, 0xffff0000, 0
    s_or_b32 exec_hi, s75, s80
    s_sub_u32 s75, s72, s74
    s_cmp_gt_u32 s75, 8
    s_cbranch_scc1 K_FP0
    s_setprio 2
    s_cmp_gt_u32 s75, 3
    s_cbranch_scc1 K_FP0
    s_setprio 1
    s_cmp_gt_u32 s75, 1
    s_cbranch_scc1 K_FP0
    s_setprio 0
K_FP0:
    s_cbranch_execz K_FQ0
    ds_write2_b32 v32, v20, v21 offset0:0 offset1:16
    ds_write2_b32 v32, v22, v23 offset0:32 offset1:48
    ds_write2_b32 v32, v44, v45 offset0:64 offset1:80
    ds_write2_b32 v32, v46, v47 offset0:96 offset1:112
    s_cmp_eq_u32 s74, s72
    s_cbranch_scc1 K_JOIN
    v_lshl_add_u64 v[32:33], v[32:33], 0, s[24:25]
    ds_read_b128 v[20:23], v30
    ds_read_b128 v[44:47], v30
    ds_read_b128 v[12:15], v33
    s_waitcnt lgkmcnt(0)
K_FQ0:
    s_mov_b64 exec, -1
    s_branch K_BACK0
K_FLUSH1:
    s_add_u32 s74, s73, 2
    s_bitcmp1_b32 s44, s74
    s_cselect_b32 s75, 0xffff, 0
    s_bitcmp1_b32 s45, s74
    s_cselect_b32 s80, 0xffff0000, 0
    s_or_b32 exec_lo, s75, s80
    s_bitcmp1_b32 s46, s74
    s_cselect_b32 s75, 0xffff, 0
    s_bitcmp1_b32 s47, s74
    s_cselect_b32 s80, 0xffff0000, 0
    s_or_b32 exec_hi, s75, s80
    s_sub_u32 s75, s72, s74
    s_cmp_gt_u32 s75, 8
    s_cbranch_scc1 K_FP1
    s_setprio 2
    s_cmp_gt_u32 s75, 3
    s_cbranch_scc1 K_FP1
    s_setprio 1
    s_cmp_gt_u32 s75, 1
    s_cbranch_scc1 K_FP1
    s_setprio 0
K_FP1:
    s_cbranch_execz K_FQ1
    ds_write2_b32 v32, v20, v21 offset0:0 offset1:16
    ds_write2_b32 v32, v22, v23 offset0:32 offset1:48
    ds_write2_b32 v32, v44, v45 offset0:64 offset1:80
    ds_write2_b32 v32, v46, v47 offset0:96 offset1:112
    s_cmp_eq_u32 s74, s72
    s_cbranch_scc1 K_JOIN
    v_lshl_add_u64 v[32:33], v[32:33], 0, s[24:25]
    ds_read_b128 v[20:23], v30
    ds_read_b128 v[44:47], v30
    ds_read_b128 v[12:15], v33
    s_waitcnt lgkmcnt(0)
K_FQ1:
    s_mov_b64 exec, -1
    s_branch K_BACK1
K_FLUSH2:
    s_add_u32 s74, s73, 3
    s_bitcmp1_b32 s44, s74
    s_cselect_b32 s75, 0xffff, 0
    s_bitcmp1_b32 s45, s74
    s_cselect_b32 s80, 0xffff0000, 0
    s_or_b32 exec_lo, s75, s80
    s_bitcmp1_b32 s46, s74
    s_cselect_b32 s75, 0xffff, 0
    s_bitcmp1_b32 s47, s74
    s_cselect_b32 s80, 0xffff0000, 0
    s_or_b32 exec_hi, s75, s80
    s_sub_u32 s75, s72, s74
    s_cmp_gt_u32 s75, 8
    s_cbranch_scc1 K_FP2
    s_setprio 2
    s_cmp_gt_u32 s75, 3
    s_cbranch_scc1 K_FP2
    s_setprio 1
    s_cmp_gt_u32 s75, 1
    s_cbranch_scc1 K_FP2
    s_setprio 0
K_FP2:
    s_cbranch_execz K_FQ2
    ds_write2_b32 v32, v20, v21 offset0:0 offset1:16
    ds_write2_b32 v32, v22, v23 offset0:32 offset1:48
    ds_write2_b32 v32, v44, v45 offset0:64 offset1:80
    ds_write2_b32 v32, v46, v47 offset0:96 offset1:112
    s_cmp_eq_u32 s74, s72
    s_cbranch_scc1 K_JOIN
    v_lshl_add_u64 v[32:33], v[32:33], 0, s[24:25]
    ds_read_b128 v[20:23], v30
    ds_read_b128 v[44:47], v30
    ds_read_b128 v[12:15], v33
    s_waitcnt lgkmcnt(0)
K_FQ2:
    s_mov_b64 exec, -1
    s_branch K_BACK2
K_FLUSH3:
    s_add_u32 s74, s73, 4
    s_bitcmp1_b32 s44, s74
    s_cselect_b32 s75, 0xffff, 0
    s_bitcmp1_b32 s45, s74
    s_cselect_b32 s80, 0xffff0000, 0
    s_or_b32 exec_lo, s75, s80
    s_bitcmp1_b32 s46, s74
    s_cselect_b32 s75, 0xffff, 0
    s_bitcmp1_b32 s47, s74
    s_cselect_b32 s80, 0xffff0000, 0
    s_or_b32 exec_hi, s75, s80
    s_sub_u32 s75, s72, s74
    s_cmp_gt_u32 s75, 8
    s_cbranch_scc1 K_FP3
    s_setprio 2
    s_cmp_gt_u32 s75, 3
    s_cbranch_scc1 K_FP3
    s_setprio 1
    s_cmp_gt_u32 s75, 1
    s_cbranch_scc1 K_FP3
    s_setprio 0
K_FP3:
    s_cbranch_execz K_FQ3
    ds_write2_b32 v32, v20, v21 offset0:0 offset1:16
    ds_write2_b32 v32, v22, v23 offset0:32 offset1:48
    ds_write2_b32 v32, v44, v45 offset0:64 offset1:80
    ds_write2_b32 v32, v46, v47 offset0:96 offset1:112
    s_cmp_eq_u32 s74, s72
    s_cbranch_scc1 K_JOIN
    v_lshl_add_u64 v[32:33], v[32:33], 0, s[24:25]
    ds_read_b128 v[20:23], v30
    ds_read_b128 v[44:47], v30
    ds_read_b128 v[12:15], v33
    s_waitcnt lgkmcnt(0)
K_FQ3:
    s_mov_b64 exec, -1
    s_branch K_BACK3
K_JOIN:
    s_mov_b64 exec, -1
    s_cmp_lt_u32 s3, 13
    s_waitcnt lgkmcnt(0)
    s_barrier
    s_cbranch_scc0 K_FIN
    ds_read_b128 v[8:11], v120
    ds_read_b128 v[16:19], v121
    ds_read_b128 v[24:27], v122
    ds_read_b128 v[12:15], v120 offset:256
    ds_read_b128 v[20:23], v121 offset:256
    ds_read_b128 v[28:31], v122 offset:256
    s_cmp_lg_u64 s[48:49], 0
    s_waitcnt lgkmcnt(3)
    v_pk_add_f32 v[8:9], v[8:9], v[16:17]
    v_pk_add_f32 v[10:11], v[10:11], v[18:19]
    v_pk_add_f32 v[8:9], v[8:9], v[24:25]
    v_pk_add_f32 v[10:11], v[10:11], v[26:27]
    s_waitcnt lgkmcnt(0)
    v_pk_add_f32 v[12:13], v[12:13], v[20:21]
    v_pk_add_f32 v[14:15], v[14:15], v[22:23]
    v_pk_add_f32 v[12:13], v[12:13], v[28:29]
    v_pk_add_f32 v[14:15], v[14:15], v[30:31]
    s_cbranch_scc1 R_LONG
K_MATH:
    v_pk_add_f32 v[8:9], v[8:9], s[18:19]
    v_pk_add_f32 v[10:11], v[10:11], s[18:19]
    v_rcp_f32 v8, v8
    v_rcp_f32 v9, v9
    v_rcp_f32 v10, v10
    v_rcp_f32 v11, v11
    s_nop 0
    v_pk_fma_f32 v[8:9], v[12:13], v[8:9], v[108:109]
    v_pk_fma_f32 v[10:11], v[14:15], v[10:11], v[110:111]
    v_max_f32 v8, 0, v8
    v_max_f32 v9, 0, v9
    v_max_f32 v10, 0, v10
    v_max_f32 v11, 0, v11
    v_pk_add_f32 v[8:9], v[8:9], v[112:113]
    v_pk_add_f32 v[10:11], v[10:11], v[114:115]
    v_cvt_pk_bf16_f32 v12, v8, v9
    v_cvt_pk_bf16_f32 v13, v10, v11
    buffer_store_dwordx2 v[12:13], v116, s[32:35], 0 offen sc1
K_FIN:
K_END:
    s_endpgm
R_PUB2:
    s_mov_b64 exec, vcc
    ds_read_b128 v[76:79], v4 offset:12672
    ds_read_b128 v[80:83], v4 offset:47488
    v_and_b32 v10, 7, v0
    v_mul_u32_u24 v10, 65538, v10
    v_add_u32 v10, 524304, v10
    s_waitcnt lgkmcnt(0)
    v_and_b32 v79, 0x3f3f3f, v79
    v_add_u32 v11, 0, v10
    v_cmp_le_u32 s[70:71], v8, v11
    v_or_b32 v11, 63, v79
    s_nop 0
    v_cndmask_b32 v79, v79, v11, s[70:71]
    v_add_u32 v11, 21846, v10
    v_cmp_le_u32 s[70:71], v8, v11
    v_or_b32 v11, 16128, v79
    s_nop 0
    v_cndmask_b32 v79, v79, v11, s[70:71]
    v_add_u32 v11, 43692, v10
    v_cmp_le_u32 s[70:71], v8, v11
    v_or_b32 v11, 4128768, v79
    s_nop 0
    v_cndmask_b32 v79, v79, v11, s[70:71]
    v_and_b32 v83, 0x3f3f3f, v83
    v_add_u32 v11, 0, v10
    v_cmp_le_u32 s[70:71], v9, v11
    v_or_b32 v11, 63, v83
    s_nop 0
    v_cndmask_b32 v83, v83, v11, s[70:71]
    v_add_u32 v11, 21846, v10
    v_cmp_le_u32 s[70:71], v9, v11
    v_or_b32 v11, 16128, v83
    s_nop 0
    v_cndmask_b32 v83, v83, v11, s[70:71]
    v_add_u32 v11, 43692, v10
    v_cmp_le_u32 s[70:71], v9, v11
    v_or_b32 v11, 4128768, v83
    s_nop 0
    v_cndmask_b32 v83, v83, v11, s[70:71]
    v_add_u32 v8, 0x900000, v6
    v_add_u32 v9, 0x900000, v7
    v_bfi_b32 v76, s40, v122, v76
    v_bfi_b32 v77, s40, v122, v77
    v_bfi_b32 v78, s40, v122, v78
    v_or_b32 v79, v123, v79
    v_bfi_b32 v80, s40, v122, v80
    v_bfi_b32 v81, s40, v122, v81
    v_bfi_b32 v82, s40, v122, v82
    v_or_b32 v83, v123, v83
    global_store_dwordx4 v8, v[76:79], s[26:27] sc1
    global_store_dwordx4 v9, v[80:83], s[26:27] sc1
    s_branch A_PUBD
B_P0_RETRY:
    s_and_b32 s72, s68, s74
    s_lshl_b32 s73, s72, 1
    s_or_b32 s72, s72, s73
    s_lshl_b32 s73, s72, 2
    s_or_b32 s72, s72, s73
    s_lshl_b32 s73, s72, 4
    s_or_b32 s72, s72, s73
    s_and_b32 s68, s68, s72
    s_and_b32 s72, s69, s75
    s_lshl_b32 s73, s72, 1
    s_or_b32 s72, s72, s73
    s_lshl_b32 s73, s72, 2
    s_or_b32 s72, s72, s73
    s_lshl_b32 s73, s72, 4
    s_or_b32 s72, s72, s73
    s_and_b32 s69, s69, s72
    s_and_b32 s72, s70, s76
    s_lshl_b32 s73, s72, 1
    s_or_b32 s72, s72, s73
    s_lshl_b32 s73, s72, 2
    s_or_b32 s72, s72, s73
    s_lshl_b32 s73, s72, 4
    s_or_b32 s72, s72, s73
    s_and_b32 s70, s70, s72
    s_and_b32 s72, s71, s77
    s_lshl_b32 s73, s72, 1
    s_or_b32 s72, s72, s73
    s_lshl_b32 s73, s72, 2
    s_or_b32 s72, s72, s73
    s_lshl_b32 s73, s72, 4
    s_or_b32 s72, s72, s73
    s_and_b32 s71, s71, s72
    s_add_u32 s43, s43, 1
    s_cmp_gt_u32 s43, 100000
    s_cbranch_scc1 R_TIMEOUT
    s_sleep 2
    s_mov_b64 exec, s[68:69]
    s_cbranch_execz B_P0_1
    global_load_dwordx4 v[8:11], v2, s[26:27] sc1
B_P0_1:
    s_mov_b64 exec, s[70:71]
    s_cbranch_execz B_P0_2
    global_load_dwordx4 v[12:15], v3, s[26:27] sc1
B_P0_2:
    s_branch B_P0
R_MORE:
    s_cmp_lg_u32 s79, 0
    s_cbranch_scc1 R_REQ
    s_lshr_b32 s74, s64, 7
    s_and_b32 s74, s74, 0x01010101
    s_mul_i32 s74, s74, 0xff
    s_lshr_b32 s75, s65, 7
    s_and_b32 s75, s75, 0x01010101
    s_mul_i32 s75, s75, 0xff
    s_lshr_b32 s76, s66, 7
    s_and_b32 s76, s76, 0x01010101
    s_mul_i32 s76, s76, 0xff
    s_lshr_b32 s77, s67, 7
    s_and_b32 s77, s77, 0x01010101
    s_mul_i32 s77, s77, 0xff
    s_mov_b64 s[68:69], s[74:75]
    s_mov_b64 s[70:71], s[76:77]
    v_add_u32 v2, 0x900000, v2
    v_add_u32 v3, 0x900000, v3
    s_mov_b64 exec, s[68:69]
    s_cbranch_execz B_N1_1
    global_load_dwordx4 v[64:67], v2, s[26:27] sc1
B_N1_1:
    s_mov_b64 exec, s[70:71]
    s_cbranch_execz B_N1_2
    global_load_dwordx4 v[68:71], v3, s[26:27] sc1
B_N1_2:
B_P1:
    s_waitcnt vmcnt(0)
    s_mov_b64 exec, s[68:69]
    v_xor_b32 v64, v122, v64
    v_xor_b32 v65, v122, v65
    v_xor_b32 v66, v122, v66
    v_xor_b32 v67, v123, v67
    s_mov_b64 exec, s[70:71]
    v_xor_b32 v68, v122, v68
    v_xor_b32 v69, v122, v69
    v_xor_b32 v70, v122, v70
    v_xor_b32 v71, v123, v71
    s_mov_b64 exec, -1
    v_or3_b32 v6, v64, v65, v66
    v_and_b32 v6, s40, v6
    v_and_or_b32 v6, v67, s41, v6
    v_cmp_ne_u32 s[68:69], 0, v6
    v_cmp_gt_u32 s[64:65], s42, v67
    v_or3_b32 v7, v68, v69, v70
    v_and_b32 v7, s40, v7
    v_and_or_b32 v7, v71, s41, v7
    v_cmp_ne_u32 s[70:71], 0, v7
    v_cmp_gt_u32 s[66:67], s42, v71
    s_and_b64 s[72:73], s[68:69], s[74:75]
    s_and_b64 s[80:81], s[70:71], s[76:77]
    s_or_b64 s[72:73], s[72:73], s[80:81]
    s_cbranch_scc1 B_P1_RETRY
    v_lshlrev_b32_sdwa v72, 2, v67 dst_sel:DWORD dst_unused:UNUSED_PAD src0_sel:DWORD src1_sel:BYTE_0
    v_lshlrev_b32_sdwa v73, 2, v67 dst_sel:DWORD dst_unused:UNUSED_PAD src0_sel:DWORD src1_sel:BYTE_1
    v_lshlrev_b32_sdwa v74, 2, v67 dst_sel:DWORD dst_unused:UNUSED_PAD src0_sel:DWORD src1_sel:BYTE_2
    v_lshlrev_b32_sdwa v75, 2, v71 dst_sel:DWORD dst_unused:UNUSED_PAD src0_sel:DWORD src1_sel:BYTE_0
    v_lshlrev_b32_sdwa v76, 2, v71 dst_sel:DWORD dst_unused:UNUSED_PAD src0_sel:DWORD src1_sel:BYTE_1
    v_lshlrev_b32_sdwa v77, 2, v71 dst_sel:DWORD dst_unused:UNUSED_PAD src0_sel:DWORD src1_sel:BYTE_2
    s_mov_b64 exec, s[74:75]
    v_cmp_gt_u32_sdwa s[4:5], 49, v67 src0_sel:DWORD src1_sel:BYTE_0
    v_cmp_gt_u32_sdwa s[6:7], 49, v67 src0_sel:DWORD src1_sel:BYTE_1
    v_cmp_gt_u32_sdwa s[8:9], 49, v67 src0_sel:DWORD src1_sel:BYTE_2
    s_mov_b64 exec, s[4:5]
    ds_add_rtn_u32 v78, v72, v31 offset:9472
    s_mov_b64 exec, s[6:7]
    ds_add_rtn_u32 v79, v73, v31 offset:9472
    s_mov_b64 exec, s[8:9]
    ds_add_rtn_u32 v80, v74, v31 offset:9472
    s_mov_b64 exec, s[76:77]
    v_cmp_gt_u32_sdwa s[10:11], 49, v71 src0_sel:DWORD src1_sel:BYTE_0
    v_cmp_gt_u32_sdwa s[12:13], 49, v71 src0_sel:DWORD src1_sel:BYTE_1
    v_cmp_gt_u32_sdwa s[14:15], 49, v71 src0_sel:DWORD src1_sel:BYTE_2
    s_mov_b64 exec, s[10:11]
    ds_add_rtn_u32 v81, v75, v31 offset:9472
    s_mov_b64 exec, s[12:13]
    ds_add_rtn_u32 v82, v76, v31 offset:9472
    s_mov_b64 exec, s[14:15]
    ds_add_rtn_u32 v83, v77, v31 offset:9472
    s_mov_b64 exec, -1
    s_or_b32 s78, s78, 1
    s_and_b64 s[64:65], s[64:65], s[74:75]
    s_and_b64 s[66:67], s[66:67], s[76:77]
    s_or_b64 s[72:73], s[64:65], s[66:67]
    s_or_b32 s72, s72, s73
    s_and_b32 s72, s72, 0x80808080
    s_cbranch_scc0 B_RDONE
    s_mov_b32 s79, 1
    s_branch R_REQ
B_P1_RETRY:
    s_and_b64 s[68:69], s[68:69], s[74:75]
    s_and_b64 s[70:71], s[70:71], s[76:77]
    s_add_u32 s43, s43, 1
    s_cmp_gt_u32 s43, 100000
    s_cbranch_scc1 R_TIMEOUT
    s_sleep 2
    s_mov_b64 exec, s[68:69]
    s_cbranch_execz B_P1_1
    global_load_dwordx4 v[64:67], v2, s[26:27] sc1
B_P1_1:
    s_mov_b64 exec, s[70:71]
    s_cbranch_execz B_P1_2
    global_load_dwordx4 v[68:71], v3, s[26:27] sc1
B_P1_2:
    s_branch B_P1
R_TIMEOUT:
    s_mov_b32 s79, 3
    s_mov_b64 s[44:45], 0
    s_mov_b64 s[46:47], 0
    s_mov_b64 s[48:49], 0
    s_mov_b64 s[50:51], 0
    s_mov_b64 s[52:53], 0
    s_mov_b64 s[54:55], 0
    v_mov_b32 v35, v123
    v_mov_b32 v33, 0x388000
R_REQ:
    v_mov_b32 v6, s79
    ds_or_b32 v1, v6 offset:9728
    s_branch B_RDONE
R_EXTRA:
    s_bitcmp1_b32 s78, 0
    s_cbranch_scc0 R_X2
    s_waitcnt lgkmcnt(0)
    ds_read_b32 v72, v72 offset:9984
    ds_read_b32 v73, v73 offset:9984
    ds_read_b32 v74, v74 offset:9984
    ds_read_b32 v75, v75 offset:9984
    ds_read_b32 v76, v76 offset:9984
    ds_read_b32 v77, v77 offset:9984
    s_waitcnt lgkmcnt(3)
    v_add3_u32 v72, v72, v78, s85
    v_add3_u32 v73, v73, v79, s85
    v_add3_u32 v74, v74, v80, s85
    s_waitcnt lgkmcnt(0)
    v_add3_u32 v75, v75, v81, s85
    v_add3_u32 v76, v76, v82, s85
    v_add3_u32 v77, v77, v83, s85
    s_mov_b64 exec, s[4:5]
    ds_write_b32 v72, v64
    s_mov_b64 exec, s[6:7]
    ds_write_b32 v73, v65
    s_mov_b64 exec, s[8:9]
    ds_write_b32 v74, v66
    s_mov_b64 exec, s[10:11]
    ds_write_b32 v75, v68
    s_mov_b64 exec, s[12:13]
    ds_write_b32 v76, v69
    s_mov_b64 exec, s[14:15]
    ds_write_b32 v77, v70
    s_mov_b64 exec, -1
R_X2:
    s_bitcmp1_b32 s78, 1
    s_cbranch_scc0 B_XDONE
    s_cmp_eq_u32 s3, 1
    s_cbranch_scc1 R_PAD
    s_add_u32 s71, s66, 1
    v_cvt_f32_u32 v48, s71
    v_cvt_f32_u32 v49, s66
    s_lshl_b32 s73, s67, 2
    s_mul_i32 s71, s71, s73
    v_rcp_f32 v48, v48
    v_rcp_f32 v49, v49
    v_cvt_f32_u32 v50, s71
    v_cvt_f32_u32 v51, s73
    v_fma_f32 v50, -v50, v49, v51
    v_mov_b32 v51, 0x3e000000
    v_cvt_f32_u32 v53, v3
    v_fma_f32 v53, v53, v51, -0.5
    v_mul_f32 v52, v53, v48
    v_fma_f32 v53, v53, v49, v50
    v_max_f32 v53, v53, v52
    v_cvt_u32_f32 v53, v53
    s_cmp_eq_u32 s3, 2
    s_cbranch_scc1 R_EPI
    s_cmp_eq_u32 s3, 3
    s_cbranch_scc1 R_FIRST
    v_min_u32 v55, s73, v53
    v_mad_u32_u24 v55, v53, s66, v55
    v_lshrrev_b32 v56, 3, v3
    v_sub_u32 v55, v56, v55
    v_lshlrev_b32 v55, v55, 1
    v_lshlrev_b32 v56, 4, v53
    s_mov_b64 exec, s[82:83]
    ds_or_b32 v56, v55 offset:10504
    s_mov_b64 exec, -1
    s_branch B_XDONE
R_FIRST:
    v_mov_b32 v54, -1
    v_cndmask_b32 v53, 63, v53, s[82:83]
    v_mul_u32_u24 v59, 200, v5
    v_add_u32 v59, 82176, v59
    v_mov_b32_dpp v54, v53 wave_shr:1 row_mask:0xf bank_mask:0xf
    v_lshl_add_u32 v58, v54, 2, v5
    v_mul_i32_i24 v58, 128, v58
    v_add_u32 v58, 12544, v58
    v_lshlrev_b32 v54, 4, v54
    v_lshlrev_b32 v53, 4, v53
R_FIRST1:
    v_cmp_lt_i32 s[74:75], v54, v53
    s_mov_b64 exec, s[74:75]
    s_cbranch_execz R_FIRST2
    v_add_u32 v54, 16, v54
    v_add_u32 v58, 512, v58
    ds_write_b64 v54, v[58:59] offset:10496
    s_branch R_FIRST1
R_FIRST2:
    s_mov_b64 exec, -1
    s_branch B_XDONE
R_EPI:
    v_cvt_f32_u32 v54, v7
    v_fma_f32 v54, v54, v51, 0.5
    v_mul_f32 v52, v54, v48
    v_fma_f32 v54, v54, v49, v50
    v_max_f32 v54, v54, v52
    v_cvt_u32_f32 v54, v54
    v_sub_u32 v59, v53, v54
    v_lshl_add_u32 v56, v54, 2, v5
    v_mul_u32_u24 v56, 128, v56
    v_add_u32 v56, 12544, v56
    v_cmp_lt_i32 s[74:75], 0, v59
    v_cmp_lt_i32 s[76:77], 1, v59
    v_add_u32 v57, 512, v56
    v_add_u32 v58, 1024, v56
    v_cndmask_b32 v57, v30, v57, s[74:75]
    v_cndmask_b32 v58, v30, v58, s[76:77]
    v_lshlrev_b32 v55, 2, v5
    ds_write_b128 v55, v[56:59] offset:11520
    s_branch B_XDONE
R_PAD:
    v_mov_b32 v52, 12500
    v_add_u32 v53, 123768, v3
    v_cmp_lt_u32 s[74:75], v6, v2
    s_mov_b64 exec, s[74:75]
    ds_write_b32 v53, v52 offset:4
    v_cmp_eq_u32 s[74:75], 0, v6
    s_mov_b64 exec, s[74:75]
    ds_write_b32 v53, v52
    s_mov_b64 exec, 0x3f
    s_add_u32 s71, s64, s85
    v_add_u32 v53, s71, v5
    ds_write_b32 v53, v52
    s_mov_b64 exec, -1
    s_cmp_eq_u32 s2, 0
    s_cbranch_scc0 B_XDONE
    s_sub_u32 s71, 0x380000, s38
    v_mov_b32 v48, s71
    v_mov_b32 v50, 0x1000000
    v_mov_b32 v51, 0
    s_mov_b64 exec, 1
    global_atomic_add_x2 v48, v[50:51], s[26:27] offset:8 sc1
    s_mov_b64 exec, -1
    s_branch B_XDONE
R_FLAGS:
    s_add_u32 s43, s43, 1
    s_cmp_gt_u32 s43, 100000
    s_cbranch_scc1 R_FLAGT
    s_sleep 2
    s_mov_b64 exec, vcc
    global_load_dword v35, v34, s[26:27] sc1
    s_waitcnt vmcnt(0)
    v_cmp_ne_u32 vcc, v123, v35
    s_mov_b64 exec, -1
    s_branch B_XDONE
R_FLAGT:
    v_mov_b32 v52, 3
    ds_or_b32 v1, v52 offset:9728
    s_branch B_FDONE
R_LONG:
    s_mov_b32 s64, 2
    s_mov_b64 vcc, s[48:49]
R_LONG1:
    s_mov_b64 exec, vcc
    v_add_u32 v122, 512, v122
    ds_read_b128 v[16:19], v122
    ds_read_b128 v[20:23], v122 offset:256
    s_add_u32 s64, s64, 1
    s_waitcnt lgkmcnt(0)
    v_pk_add_f32 v[8:9], v[8:9], v[16:17]
    v_pk_add_f32 v[10:11], v[10:11], v[18:19]
    v_pk_add_f32 v[12:13], v[12:13], v[20:21]
    v_pk_add_f32 v[14:15], v[14:15], v[22:23]
    v_cmp_lt_i32 vcc, s64, v123
    s_cbranch_vccnz R_LONG1
    s_mov_b64 exec, -1
    s_branch K_MATH
K_SLOW:
    s_load_dwordx8 s[4:11], s[0:1], 0
    s_load_dwordx2 s[12:13], s[0:1], 40
    s_load_dwordx2 s[14:15], s[0:1], 64
    s_setprio 0
    s_waitcnt vmcnt(0) lgkmcnt(0)
    s_cmp_eq_u32 s3, 15
    s_cselect_b32 s71, s80, 0
    s_and_b32 s71, s71, 2
    s_cbranch_scc0 K_SL0
    s_sub_u32 s71, 0x380000, s38
    v_mov_b32 v48, s71
    v_mov_b32 v50, 0x1000000
    v_mov_b32 v51, 0
    s_mov_b64 exec, 1
    global_atomic_add_x2 v48, v[50:51], s[26:27] offset:8 sc1
    s_mov_b64 exec, -1
    s_waitcnt vmcnt(0)
K_SL0:
    v_lshrrev_b32 v6, 1, v5
    v_add_u32 v7, 4096, v6
    global_load_ushort v40, v6, s[12:13] offset:0
    global_load_ushort v8, v6, s[12:13] offset:128
    global_load_ushort v41, v6, s[12:13] offset:256
    global_load_ushort v9, v6, s[12:13] offset:384
    global_load_ushort v42, v6, s[12:13] offset:512
    global_load_ushort v10, v6, s[12:13] offset:640
    global_load_ushort v43, v6, s[12:13] offset:768
    global_load_ushort v11, v6, s[12:13] offset:896
    global_load_ushort v44, v6, s[12:13] offset:1024
    global_load_ushort v12, v6, s[12:13] offset:1152
    global_load_ushort v45, v6, s[12:13] offset:1280
    global_load_ushort v13, v6, s[12:13] offset:1408
    global_load_ushort v46, v6, s[12:13] offset:1536
    global_load_ushort v14, v6, s[12:13] offset:1664
    global_load_ushort v47, v6, s[12:13] offset:1792
    global_load_ushort v15, v6, s[12:13] offset:1920
    global_load_ushort v48, v6, s[12:13] offset:2048
    global_load_ushort v16, v6, s[12:13] offset:2176
    global_load_ushort v49, v6, s[12:13] offset:2304
    global_load_ushort v17, v6, s[12:13] offset:2432
    global_load_ushort v50, v6, s[12:13] offset:2560
    global_load_ushort v18, v6, s[12:13] offset:2688
    global_load_ushort v51, v6, s[12:13] offset:2816
    global_load_ushort v19, v6, s[12:13] offset:2944
    global_load_ushort v52, v6, s[12:13] offset:3072
    global_load_ushort v20, v6, s[12:13] offset:3200
    global_load_ushort v53, v6, s[12:13] offset:3328
    global_load_ushort v21, v6, s[12:13] offset:3456
    global_load_ushort v54, v6, s[12:13] offset:3584
    global_load_ushort v22, v6, s[12:13] offset:3712
    global_load_ushort v55, v6, s[12:13] offset:3840
    global_load_ushort v23, v6, s[12:13] offset:3968
    s_waitcnt vmcnt(0)
    v_lshl_or_b32 v40, v8, 16, v40
    v_lshl_or_b32 v41, v9, 16, v41
    v_lshl_or_b32 v42, v10, 16, v42
    v_lshl_or_b32 v43, v11, 16, v43
    v_lshl_or_b32 v44, v12, 16, v44
    v_lshl_or_b32 v45, v13, 16, v45
    v_lshl_or_b32 v46, v14, 16, v46
    v_lshl_or_b32 v47, v15, 16, v47
    v_lshl_or_b32 v48, v16, 16, v48
    v_lshl_or_b32 v49, v17, 16, v49
    v_lshl_or_b32 v50, v18, 16, v50
    v_lshl_or_b32 v51, v19, 16, v51
    v_lshl_or_b32 v52, v20, 16, v52
    v_lshl_or_b32 v53, v21, 16, v53
    v_lshl_or_b32 v54, v22, 16, v54
    v_lshl_or_b32 v55, v23, 16, v55
    global_load_ushort v56, v7, s[12:13] offset:0
    global_load_ushort v8, v7, s[12:13] offset:128
    global_load_ushort v57, v7, s[12:13] offset:256
    global_load_ushort v9, v7, s[12:13] offset:384
    global_load_ushort v58, v7, s[12:13] offset:512
    global_load_ushort v10, v7, s[12:13] offset:640
    global_load_ushort v59, v7, s[12:13] offset:768
    global_load_ushort v11, v7, s[12:13] offset:896
    global_load_ushort v60, v7, s[12:13] offset:1024
    global_load_ushort v12, v7, s[12:13] offset:1152
    global_load_ushort v61, v7, s[12:13] offset:1280
    global_load_ushort v13, v7, s[12:13] offset:1408
    global_load_ushort v62, v7, s[12:13] offset:1536
    global_load_ushort v14, v7, s[12:13] offset:1664
    global_load_ushort v63, v7, s[12:13] offset:1792
    global_load_ushort v15, v7, s[12:13] offset:1920
    global_load_ushort v64, v7, s[12:13] offset:2048
    global_load_ushort v16, v7, s[12:13] offset:2176
    global_load_ushort v65, v7, s[12:13] offset:2304
    global_load_ushort v17, v7, s[12:13] offset:2432
    global_load_ushort v66, v7, s[12:13] offset:2560
    global_load_ushort v18, v7, s[12:13] offset:2688
    global_load_ushort v67, v7, s[12:13] offset:2816
    global_load_ushort v19, v7, s[12:13] offset:2944
    global_load_ushort v68, v7, s[12:13] offset:3072
    global_load_ushort v20, v7, s[12:13] offset:3200
    global_load_ushort v69, v7, s[12:13] offset:3328
    global_load_ushort v21, v7, s[12:13] offset:3456
    global_load_ushort v70, v7, s[12:13] offset:3584
    global_load_ushort v22, v7, s[12:13] offset:3712
    global_load_ushort v71, v7, s[12:13] offset:3840
    global_load_ushort v23, v7, s[12:13] offset:3968
    s_waitcnt vmcnt(0)
    v_lshl_or_b32 v56, v8, 16, v56
    v_lshl_or_b32 v57, v9, 16, v57
    v_lshl_or_b32 v58, v10, 16, v58
    v_lshl_or_b32 v59, v11, 16, v59
    v_lshl_or_b32 v60, v12, 16, v60
    v_lshl_or_b32 v61, v13, 16, v61
    v_lshl_or_b32 v62, v14, 16, v62
    v_lshl_or_b32 v63, v15, 16, v63
    v_lshl_or_b32 v64, v16, 16, v64
    v_lshl_or_b32 v65, v17, 16, v65
    v_lshl_or_b32 v66, v18, 16, v66
    v_lshl_or_b32 v67, v19, 16, v67
    v_lshl_or_b32 v68, v20, 16, v68
    v_lshl_or_b32 v69, v21, 16, v69
    v_lshl_or_b32 v70, v22, 16, v70
    v_lshl_or_b32 v71, v23, 16, v71
    global_load_ushort v72, v6, s[14:15] offset:0
    global_load_ushort v8, v6, s[14:15] offset:128
    global_load_ushort v73, v6, s[14:15] offset:256
    global_load_ushort v9, v6, s[14:15] offset:384
    global_load_ushort v74, v6, s[14:15] offset:512
    global_load_ushort v10, v6, s[14:15] offset:640
    global_load_ushort v75, v6, s[14:15] offset:768
    global_load_ushort v11, v6, s[14:15] offset:896
    global_load_ushort v76, v6, s[14:15] offset:1024
    global_load_ushort v12, v6, s[14:15] offset:1152
    global_load_ushort v77, v6, s[14:15] offset:1280
    global_load_ushort v13, v6, s[14:15] offset:1408
    global_load_ushort v78, v6, s[14:15] offset:1536
    global_load_ushort v14, v6, s[14:15] offset:1664
    global_load_ushort v79, v6, s[14:15] offset:1792
    global_load_ushort v15, v6, s[14:15] offset:1920
    global_load_ushort v80, v6, s[14:15] offset:2048
    global_load_ushort v16, v6, s[14:15] offset:2176
    global_load_ushort v81, v6, s[14:15] offset:2304
    global_load_ushort v17, v6, s[14:15] offset:2432
    global_load_ushort v82, v6, s[14:15] offset:2560
    global_load_ushort v18, v6, s[14:15] offset:2688
    global_load_ushort v83, v6, s[14:15] offset:2816
    global_load_ushort v19, v6, s[14:15] offset:2944
    global_load_ushort v84, v6, s[14:15] offset:3072
    global_load_ushort v20, v6, s[14:15] offset:3200
    global_load_ushort v85, v6, s[14:15] offset:3328
    global_load_ushort v21, v6, s[14:15] offset:3456
    global_load_ushort v86, v6, s[14:15] offset:3584
    global_load_ushort v22, v6, s[14:15] offset:3712
    global_load_ushort v87, v6, s[14:15] offset:3840
    global_load_ushort v23, v6, s[14:15] offset:3968
    s_waitcnt vmcnt(0)
    v_lshl_or_b32 v72, v8, 16, v72
    v_lshl_or_b32 v73, v9, 16, v73
    v_lshl_or_b32 v74, v10, 16, v74
    v_lshl_or_b32 v75, v11, 16, v75
    v_lshl_or_b32 v76, v12, 16, v76
    v_lshl_or_b32 v77, v13, 16, v77
    v_lshl_or_b32 v78, v14, 16, v78
    v_lshl_or_b32 v79, v15, 16, v79
    v_lshl_or_b32 v80, v16, 16, v80
    v_lshl_or_b32 v81, v17, 16, v81
    v_lshl_or_b32 v82, v18, 16, v82
    v_lshl_or_b32 v83, v19, 16, v83
    v_lshl_or_b32 v84, v20, 16, v84
    v_lshl_or_b32 v85, v21, 16, v85
    v_lshl_or_b32 v86, v22, 16, v86
    v_lshl_or_b32 v87, v23, 16, v87
    global_load_ushort v88, v7, s[14:15] offset:0
    global_load_ushort v8, v7, s[14:15] offset:128
    global_load_ushort v89, v7, s[14:15] offset:256
    global_load_ushort v9, v7, s[14:15] offset:384
    global_load_ushort v90, v7, s[14:15] offset:512
    global_load_ushort v10, v7, s[14:15] offset:640
    global_load_ushort v91, v7, s[14:15] offset:768
    global_load_ushort v11, v7, s[14:15] offset:896
    global_load_ushort v92, v7, s[14:15] offset:1024
    global_load_ushort v12, v7, s[14:15] offset:1152
    global_load_ushort v93, v7, s[14:15] offset:1280
    global_load_ushort v13, v7, s[14:15] offset:1408
    global_load_ushort v94, v7, s[14:15] offset:1536
    global_load_ushort v14, v7, s[14:15] offset:1664
    global_load_ushort v95, v7, s[14:15] offset:1792
    global_load_ushort v15, v7, s[14:15] offset:1920
    global_load_ushort v96, v7, s[14:15] offset:2048
    global_load_ushort v16, v7, s[14:15] offset:2176
    global_load_ushort v97, v7, s[14:15] offset:2304
    global_load_ushort v17, v7, s[14:15] offset:2432
    global_load_ushort v98, v7, s[14:15] offset:2560
    global_load_ushort v18, v7, s[14:15] offset:2688
    global_load_ushort v99, v7, s[14:15] offset:2816
    global_load_ushort v19, v7, s[14:15] offset:2944
    global_load_ushort v100, v7, s[14:15] offset:3072
    global_load_ushort v20, v7, s[14:15] offset:3200
    global_load_ushort v101, v7, s[14:15] offset:3328
    global_load_ushort v21, v7, s[14:15] offset:3456
    global_load_ushort v102, v7, s[14:15] offset:3584
    global_load_ushort v22, v7, s[14:15] offset:3712
    global_load_ushort v103, v7, s[14:15] offset:3840
    global_load_ushort v23, v7, s[14:15] offset:3968
    s_waitcnt vmcnt(0)
    v_lshl_or_b32 v88, v8, 16, v88
    v_lshl_or_b32 v89, v9, 16, v89
    v_lshl_or_b32 v90, v10, 16, v90
    v_lshl_or_b32 v91, v11, 16, v91
    v_lshl_or_b32 v92, v12, 16, v92
    v_lshl_or_b32 v93, v13, 16, v93
    v_lshl_or_b32 v94, v14, 16, v94
    v_lshl_or_b32 v95, v15, 16, v95
    v_lshl_or_b32 v96, v16, 16, v96
    v_lshl_or_b32 v97, v17, 16, v97
    v_lshl_or_b32 v98, v18, 16, v98
    v_lshl_or_b32 v99, v19, 16, v99
    v_lshl_or_b32 v100, v20, 16, v100
    v_lshl_or_b32 v101, v21, 16, v101
    v_lshl_or_b32 v102, v22, 16, v102
    v_lshl_or_b32 v103, v23, 16, v103
    v_mov_b32 v28, 0
    v_mov_b32 v29, 0
    v_mov_b32 v30, 0
    v_mov_b32 v31, 0
    v_lshlrev_b32 v8, 4, v0
    ds_write_b128 v8, v[28:31] offset:12544
    ds_write_b128 v8, v[28:31] offset:28928
    ds_write_b128 v8, v[28:31] offset:45312
    ds_write_b128 v8, v[28:31] offset:61696
    ds_read_u16 v18, v6 offset:8192
    s_mov_b32 s18, 0x358637bd
    s_mov_b32 s19, s18
    s_mov_b32 s16, 0xbfb8aa3b
    v_lshl_add_u32 v17, v124, 2, v4
    v_lshlrev_b32 v10, 1, v5
    s_waitcnt lgkmcnt(0)
    v_lshlrev_b32 v18, 16, v18
    s_barrier
    v_lshlrev_b32 v8, 2, v0
    v_lshlrev_b32 v9, 1, v0
    s_lshl_b32 s70, s3, 6
K_SLOOP:
    global_load_dword v11, v8, s[10:11]
    global_load_dword v12, v8, s[8:9]
    global_load_ushort v13, v9, s[6:7]
    s_waitcnt vmcnt(0)
    v_and_b32 v14, 0xff, v11
    v_cmp_eq_u32 s[74:75], s2, v14
K_SIN:
    s_cmp_eq_u64 s[74:75], 0
    s_cbranch_scc1 K_SNEXT
    s_ff1_i32_b64 s73, s[74:75]
    s_bitset0_b64 s[74:75], s73
    v_readlane_b32 s79, v11, s73
    v_readlane_b32 s80, v12, s73
    v_readlane_b32 s81, v13, s73
    s_lshr_b32 s79, s79, 8
    s_mul_i32 s76, s79, 800
    s_add_u32 s76, s76, 82688
    s_mul_i32 s79, s79, 1056
    s_lshl_b32 s80, s80, 7
    s_add_u32 s78, s80, 64
    s_load_dwordx16 s[36:51], s[4:5], s80
    s_load_dwordx16 s[52:67], s[4:5], s78
    s_lshl_b32 s81, s81, 16
    v_add_u32 v15, s76, v17
    v_add_u32 v16, s79, v10
    ds_read_b32 v22, v15
    v_mul_f32 v20, s81, v18
    v_mov_b32 v21, 0
    s_waitcnt lgkmcnt(0)
    v_dot2_f32_bf16 v20, s36, v40, v20
    v_dot2_f32_bf16 v21, s36, v72, v21
    v_dot2_f32_bf16 v20, s37, v41, v20
    v_dot2_f32_bf16 v21, s37, v73, v21
    v_dot2_f32_bf16 v20, s38, v42, v20
    v_dot2_f32_bf16 v21, s38, v74, v21
    v_dot2_f32_bf16 v20, s39, v43, v20
    v_dot2_f32_bf16 v21, s39, v75, v21
    v_dot2_f32_bf16 v20, s40, v44, v20
    v_dot2_f32_bf16 v21, s40, v76, v21
    v_dot2_f32_bf16 v20, s41, v45, v20
    v_dot2_f32_bf16 v21, s41, v77, v21
    v_dot2_f32_bf16 v20, s42, v46, v20
    v_dot2_f32_bf16 v21, s42, v78, v21
    v_dot2_f32_bf16 v20, s43, v47, v20
    v_dot2_f32_bf16 v21, s43, v79, v21
    v_dot2_f32_bf16 v20, s44, v48, v20
    v_dot2_f32_bf16 v21, s44, v80, v21
    v_dot2_f32_bf16 v20, s45, v49, v20
    v_dot2_f32_bf16 v21, s45, v81, v21
    v_dot2_f32_bf16 v20, s46, v50, v20
    v_dot2_f32_bf16 v21, s46, v82, v21
    v_dot2_f32_bf16 v20, s47, v51, v20
    v_dot2_f32_bf16 v21, s47, v83, v21
    v_dot2_f32_bf16 v20, s48, v52, v20
    v_dot2_f32_bf16 v21, s48, v84, v21
    v_dot2_f32_bf16 v20, s49, v53, v20
    v_dot2_f32_bf16 v21, s49, v85, v21
    v_dot2_f32_bf16 v20, s50, v54, v20
    v_dot2_f32_bf16 v21, s50, v86, v21
    v_dot2_f32_bf16 v20, s51, v55, v20
    v_dot2_f32_bf16 v21, s51, v87, v21
    v_dot2_f32_bf16 v20, s52, v56, v20
    v_dot2_f32_bf16 v21, s52, v88, v21
    v_dot2_f32_bf16 v20, s53, v57, v20
    v_dot2_f32_bf16 v21, s53, v89, v21
    v_dot2_f32_bf16 v20, s54, v58, v20
    v_dot2_f32_bf16 v21, s54, v90, v21
    v_dot2_f32_bf16 v20, s55, v59, v20
    v_dot2_f32_bf16 v21, s55, v91, v21
    v_dot2_f32_bf16 v20, s56, v60, v20
    v_dot2_f32_bf16 v21, s56, v92, v21
    v_dot2_f32_bf16 v20, s57, v61, v20
    v_dot2_f32_bf16 v21, s57, v93, v21
    v_dot2_f32_bf16 v20, s58, v62, v20
    v_dot2_f32_bf16 v21, s58, v94, v21
    v_dot2_f32_bf16 v20, s59, v63, v20
    v_dot2_f32_bf16 v21, s59, v95, v21
    v_dot2_f32_bf16 v20, s60, v64, v20
    v_dot2_f32_bf16 v21, s60, v96, v21
    v_dot2_f32_bf16 v20, s61, v65, v20
    v_dot2_f32_bf16 v21, s61, v97, v21
    v_dot2_f32_bf16 v20, s62, v66, v20
    v_dot2_f32_bf16 v21, s62, v98, v21
    v_dot2_f32_bf16 v20, s63, v67, v20
    v_dot2_f32_bf16 v21, s63, v99, v21
    v_dot2_f32_bf16 v20, s64, v68, v20
    v_dot2_f32_bf16 v21, s64, v100, v21
    v_dot2_f32_bf16 v20, s65, v69, v20
    v_dot2_f32_bf16 v21, s65, v101, v21
    v_dot2_f32_bf16 v20, s66, v70, v20
    v_dot2_f32_bf16 v21, s66, v102, v21
    v_dot2_f32_bf16 v20, s67, v71, v20
    v_dot2_f32_bf16 v21, s67, v103, v21
    s_nop 2
    v_fma_f32 v20, v20, s16, v22
    v_exp_f32 v20, v20
    s_nop 0
    v_add_f32 v20, 1.0, v20
    v_rcp_f32 v20, v20
    s_nop 0
    v_mul_f32 v21, v21, v20
    v_cvt_f64_f32 v[24:25], v20
    v_cvt_f64_f32 v[26:27], v21
    ds_add_f64 v16, v[24:25] offset:12544
    ds_add_f64 v16, v[26:27] offset:13056
    s_branch K_SIN
K_SNEXT:
    s_add_u32 s70, s70, 1024
    v_add_u32 v8, 4096, v8
    v_add_u32 v9, 2048, v9
    s_cmp_lt_u32 s70, 800000
    s_cbranch_scc1 K_SLOOP
    v_lshrrev_b32 v6, 4, v0
    v_mul_u32_u24 v6, 1056, v6
    v_lshl_add_u32 v6, v4, 1, v6
    s_waitcnt lgkmcnt(0)
    s_barrier
    s_cmp_lt_u32 s3, 13
    s_cbranch_scc0 K_FIN
    ds_read_b128 v[16:19], v6 offset:12544
    ds_read_b128 v[20:23], v6 offset:12560
    ds_read_b128 v[24:27], v6 offset:13056
    ds_read_b128 v[28:31], v6 offset:13072
    s_waitcnt lgkmcnt(0)
    v_cvt_f32_f64 v8, v[16:17]
    v_cvt_f32_f64 v9, v[18:19]
    v_cvt_f32_f64 v10, v[20:21]
    v_cvt_f32_f64 v11, v[22:23]
    v_cvt_f32_f64 v12, v[24:25]
    v_cvt_f32_f64 v13, v[26:27]
    v_cvt_f32_f64 v14, v[28:29]
    v_cvt_f32_f64 v15, v[30:31]
    s_branch K_MATH
SLOW_END:
.section .rodata,"a"
.p2align 6
.amdhsa_kernel standalone__edge_featured_mpnn_gatedgcn__graph_kernel
  .amdhsa_next_free_vgpr 128
  .amdhsa_next_free_sgpr 102
  .amdhsa_accum_offset 128
  .amdhsa_group_segment_fixed_size 0
  .amdhsa_kernarg_size 96
  .amdhsa_user_sgpr_count 2
  .amdhsa_user_sgpr_kernarg_segment_ptr 1
  .amdhsa_system_sgpr_workgroup_id_x 1
.end_amdhsa_kernel
```
